```python
import torch

def _softmax(x, axis=-1):
    return torch.softmax(x, dim=axis)
def _gelu(x):
    return torch.nn.functional.gelu(x, approximate="tanh")
def _silu(x):
    return torch.nn.functional.silu(x)
def _sigmoid(x):
    return torch.sigmoid(x)
def _layernorm(x, axis=-1, eps=1e-5):
    m = x.mean(dim=axis, keepdim=True)
    v = x.var(dim=axis, keepdim=True, unbiased=False)
    return (x - m) / torch.sqrt(v + eps)
def _scatter_add(tgt, idx, src, axis=0):
    return tgt.clone().index_add_(axis, idx, src)
def _segment_sum(src, seg, n):
    out = torch.zeros((n,) + src.shape[1:], dtype=src.dtype)
    return out.index_add_(0, seg, src)
def _pad(x, pw):
    flat = tuple(v for pair in reversed(pw) for v in pair)
    return torch.nn.functional.pad(x, flat)

kernel_name = 'concat_heads__ssm_conv_h3__sliding_block__prompt'

def setup_inputs():

    _w = (lambda a: (lambda t: t.to(torch.bfloat16) if t.is_floating_point() else t)(torch.as_tensor(a)))
    def _A_setup():
        B, S, D = 1, 2048, 512
        ks = 4
        return {
            "q": _w((lambda *s: torch.randn(*s, dtype=torch.bfloat16) * 0.05)(B, S, D)),
            "k": _w((lambda *s: torch.randn(*s, dtype=torch.bfloat16) * 0.8)(B, S, D)),
            "v": _w((lambda *s: torch.randn(*s, dtype=torch.bfloat16) * 0.8)(B, S, D)),
            "shift_k": _w((lambda *s: torch.randn(*s, dtype=torch.bfloat16) * 0.8)(D, ks) * 0.5),
            "ssm_k": _w((lambda *s: torch.randn(*s, dtype=torch.bfloat16) * 1.6)(D, S) * (1.0 / S ** 0.5)),
            "ssm_D": _w((lambda *s: torch.randn(*s, dtype=torch.bfloat16) * 0.8)(D)),
        }
    _A_in = _A_setup()

    def _B_setup():
        B, S, D = 1, 2048, 512
        return {
            "x": _w((lambda *s: torch.randn(*s, dtype=torch.bfloat16) * 0.2)(B, S, D)),
            "wqkv": _w((lambda *s: torch.randn(*s, dtype=torch.bfloat16) * 0.2)(D, 3 * D)),
            "wo": _w((lambda *s: torch.randn(*s, dtype=torch.bfloat16) * 0.05)(D, D)),
        }
    _B_in = _B_setup()

    return {
        "A_q": _A_in["q"],
        "A_k": _A_in["k"],
        "A_v": _A_in["v"],
        "A_shift_k": _A_in["shift_k"],
        "A_ssm_k": _A_in["ssm_k"],
        "A_ssm_D": _A_in["ssm_D"],
        "B_x": _B_in["x"],
        "B_wqkv": _B_in["wqkv"],
        "B_wo": _B_in["wo"],
    }

def reference(A_q, A_k, A_v, A_shift_k, A_ssm_k, A_ssm_D, B_x, B_wqkv, B_wo):
    def _A_ref(q, k, v, shift_k, ssm_k, ssm_D):
        B, S, D = q.shape
        ks = shift_k.shape[-1]
        k_pad = _pad(k, ((0, 0), (ks - 1, 0), (0, 0)))
        k_shift = torch.zeros_like(k)
        for t in range(ks):
            k_shift = k_shift + k_pad[:, t:t + S, :] * shift_k[:, ks - 1 - t][None, None, :]
        kv = k_shift * v
        L = 2 * S
        kv_pad = _pad(kv, ((0, 0), (0, S), (0, 0)))
        kf_pad = _pad(ssm_k, ((0, 0), (0, S)))
        kv_f = (lambda x, axes=(-2,-1): torch.fft.rfft2(x.float(), dim=axes))(kv_pad[:, None, :, :], axes=(1, 2))
        kf_f = (lambda x, axes=(-2,-1): torch.fft.rfft2(x.float(), dim=axes))(kf_pad[:, None, :], axes=(1, 2))
        kf_f = (lambda x, *d: x.permute(*d))(kf_f, 1, 2, 0)
        y_f = kv_f * kf_f[None, :, :, :]
        y = (lambda x, s, axes=(-2,-1): torch.fft.irfft2(x, s=s, dim=axes).to(torch.bfloat16))(y_f, (1, L), axes=(1, 2))[:, 0, :S, :]
        y = y + kv * ssm_D[None, None, :]
        return q * y

    def _B_ref(x, wqkv, wo):
        B, S, D = x.shape
        H = 32; Dh = D // H; W = 256
        qkv = (lambda x, *d: x.permute(*d))((x @ wqkv).reshape(B, S, 3, H, Dh), 2, 0, 3, 1, 4)
        q, k, v = qkv[0], qkv[1], qkv[2]
        scores = torch.einsum("bhqd,bhkd->bhqk", q, k) * (Dh ** -0.5)
        idx = torch.arange(S)
        mask = (idx[:, None] - idx[None, :] >= 0) & (idx[:, None] - idx[None, :] < W)
        scores = torch.where(mask[None, None], scores, -1e9)
        p = _softmax(scores, axis=-1)
        o = torch.einsum("bhqk,bhkd->bhqd", p, v)
        return (lambda x, *d: x.permute(*d))(o, 0, 2, 1, 3).reshape(B, S, D) @ wo

    a = _A_ref(A_q, A_k, A_v, A_shift_k, A_ssm_k, A_ssm_D)
    b = _B_ref(B_x, B_wqkv, B_wo)
    return torch.concatenate([a, b], axis=-1)
```

```asm
; @launch grid=(256,1,1) block=(512,1,1) lds=163840
.amdgcn_target "amdgcn-amd-amdhsa--gfx950"
.text
.globl concat_heads__ssm_conv_h3__sliding_block__prompt_kernel
.p2align 12
.p2align 8
.type concat_heads__ssm_conv_h3__sliding_block__prompt_kernel,@function
concat_heads__ssm_conv_h3__sliding_block__prompt_kernel:
    s_cmp_ge_u32 s2, 256
    s_cbranch_scc1 L_end
    s_load_dwordx16 s[16:31], s[0:1], 0
    s_load_dwordx8 s[32:39], s[0:1], 64
    s_getpc_b64 s[14:15]
L_pc:
    s_lshl_b32 s11, s2, 7
    s_andn2_b32 s11, s11, 0x3ff
    v_and_b32 v1, 0x1c0, v0
    v_lshl_add_u32 v1, v1, 1, s11
    v_min_u32 v1, L_slow0-L_pc-4, v1
    global_load_dword v23, v1, s[14:15]
    v_lshrrev_b32 v1, 6, v0
    v_and_b32 v0, 63, v0
    v_readfirstlane_b32 s3, v1
    s_and_b32 s4, s2, 7
    s_lshr_b32 s5, s2, 3
    s_lshr_b32 s6, s5, 4
    s_lshl_b32 s11, s4, 1
    s_add_u32 s6, s6, s11
    s_and_b32 s7, s5, 15
    s_mov_b32 s76, s7
    s_lshl_b32 s8, s6, 2
    s_add_u32 s8, s8, s7
    s_add_u32 s8, s8, s4
    s_and_b32 s8, s8, 7
    s_and_b32 s9, s3, 3
    s_or_b32 s11, s2, s3
    s_cbranch_scc1 L_nolead
    s_mov_b32 s10, 0x9e3779b9
    s_mov_b32 s11, 6619136
    s_waitcnt lgkmcnt(0)
    s_atomic_add s10, s[38:39], s11 glc
    s_waitcnt lgkmcnt(0)
    s_add_u32 s10, s10, 0x9e3779b9
    s_max_u32 s10, s10, 1
    s_atomic_add s10, s[36:37], 0
L_nolead:
    s_cmp_ge_u32 s3, 4
    s_cbranch_scc0 L_brole
    s_setprio 1
    v_lshrrev_b32 v1, 3, v0
    v_and_b32 v31, 7, v0
    v_lshrrev_b32 v26, 4, v0
    v_xor_b32 v27, v31, v26
    v_lshlrev_b32 v27, 4, v27
    v_lshl_add_u32 v2, v1, 10, v27
    v_xor_b32 v3, 64, v2
    v_add_u32 v3, 7168, v3
    v_add_u32 v4, 14336, v2
    v_add_u32 v5, 14336, v3
    v_and_b32 v27, 1, v26
    v_lshlrev_b32 v27, 2, v27
    v_xor_b32 v27, v27, v31
    v_lshlrev_b32 v27, 4, v27
    v_mul_u32_u24 v6, 3072, v1
    v_add_u32 v6, v6, v27
    v_add_u32 v7, 23552, v6
    v_lshlrev_b32 v27, 4, v31
    v_lshl_add_u32 v8, v1, 10, v27
    s_lshl_b32 s83, s6, 2
    s_add_u32 s83, s83, s9
    s_lshl_b32 s83, s83, 15
    s_mul_i32 s11, s9, 49152
    s_lshl_b32 s84, s7, 7
    s_add_u32 s84, s84, 1024
    s_add_u32 s84, s84, s11
    s_lshl_b32 s88, s5, 16
    s_lshl_b32 s11, s4, 7
    s_add_u32 s88, s88, s11
    s_sub_u32 s89, s88, 8192
    s_cmp_eq_u32 s5, 0
    s_cselect_b32 s89, 0x10000000, s89
    s_lshl_b32 s90, s9, 3
    s_lshl_b32 s90, 0xff, s90
    s_lshl_b32 s11, s9, 14
    s_add_u32 s88, s88, s11
    s_add_u32 s85, s88, 8192
    s_mul_i32 s87, s9, 2080
    s_lshl_b32 s67, s9, 12
    s_lshl_b32 s81, s9, 11
    s_lshl_b32 s92, s4, 9
    v_lshlrev_b32 v9, 4, v0
    s_lshl_b32 s93, s4, 5
    s_add_u32 s93, s93, s5
    s_lshl_b32 s12, s93, 2
    s_add_u32 s93, s12, s9
    s_lshl_b32 s66, s93, 11
    s_or_b32 s13, s66, 2048
    s_sub_u32 s13, s13, 8
    s_mov_b32 s54, 0x200000
    s_mov_b32 s55, 0x20000
    s_mov_b32 s58, 0x200000
    s_mov_b32 s59, 0x20000
    s_mov_b32 s46, 0x200000
    s_mov_b32 s47, 0x20000
    s_mov_b32 s50, 0x180000
    s_mov_b32 s51, 0x20000
    s_mov_b32 s62, 0x200000
    s_mov_b32 s63, 0x20000
    s_waitcnt lgkmcnt(0)
    s_mov_b32 s60, s24
    s_mov_b32 s61, s25
    s_mov_b32 s52, s18
    s_mov_b32 s53, s19
    s_mov_b32 s44, s28
    s_mov_b32 s45, s29
    s_mov_b32 s48, s30
    s_mov_b32 s49, s31
    buffer_load_dwordx4 v[64:67], v9, s[60:63], s66 offen offset:0
    buffer_load_dwordx4 v[68:71], v9, s[60:63], s66 offen offset:1024
    s_add_u32 m0, s87, 121104
    s_nop 0
    buffer_load_dwordx4 v8, s[52:55], s88 offen lds
    s_add_u32 m0, s87, 122144
    s_mov_b32 s56, s20
    s_mov_b32 s57, s21
    buffer_load_dwordx4 v8, s[52:55], s85 offen lds
    s_add_u32 m0, s87, 152832
    s_load_dword s91, s[26:27], s12
    buffer_load_dwordx4 v8, s[56:59], s88 offen lds
    s_add_u32 m0, s87, 153872
    s_load_dwordx2 s[64:65], s[24:25], s13
    buffer_load_dwordx4 v8, s[56:59], s85 offen lds
    s_mov_b32 m0, 120064
    s_mov_b32 exec_lo, 0
    s_mov_b32 exec_hi, s90
    buffer_load_dwordx4 v8, s[52:55], s89 offen lds
    s_mov_b32 s68, s22
    s_mov_b32 s69, s23
    s_mov_b32 s70, 4096
    s_mov_b32 s71, 0x20000
    s_mov_b32 m0, 161280
    s_mov_b32 exec_hi, 0
    s_mov_b32 exec_lo, s90
    buffer_load_dwordx4 v9, s[68:71], s92 offen lds
    s_mov_b64 exec, -1
    s_add_u32 m0, s67, 0
    s_add_u32 s11, s8, 0
    s_and_b32 s11, s11, 7
    s_lshl_b32 s85, s11, 7
    s_add_u32 s85, s85, s83
    s_mul_i32 s86, s11, 196608
    s_add_u32 s86, s86, s84
    buffer_load_dwordx4 v2, s[44:47], s85 offen offset:0 lds
    buffer_load_dwordx4 v3, s[44:47], s85 offen offset:1024 lds
    buffer_load_dwordx4 v4, s[44:47], s85 offen offset:2048 lds
    buffer_load_dwordx4 v5, s[44:47], s85 offen offset:3072 lds
    s_add_u32 m0, s81, 90112
    s_nop 0
    buffer_load_dwordx4 v6, s[48:51], s86 offen offset:0 lds
    buffer_load_dwordx4 v7, s[48:51], s86 offen offset:1024 lds
    s_mov_b32 s40, s38
    s_mov_b32 s41, s39
    s_mov_b32 s42, 8388608
    s_mov_b32 s43, 0x20000
    v_lshrrev_b32 v26, 2, v0
    v_mul_u32_u24 v10, 3072, v26
    v_and_b32 v26, 3, v0
    v_lshl_add_u32 v10, v26, 4, v10
    v_lshlrev_b32 v9, 4, v0
    s_lshl_b32 s89, s3, 7
    s_add_u32 s89, s89, 92672
    v_and_b32 v29, 31, v0
    v_lshl_add_u32 v24, v29, 2, s89
    v_and_b32 v27, 3, v0
    v_lshlrev_b32 v27, 7, v27
    v_lshl_add_u32 v29, v29, 2, v27
    v_add_u32 v25, 93184, v29
    v_add_u32 v30, 92672, v29
    v_xor_b32 v62, 0x80, v24
    v_subrev_u32 v59, 512, v24
    s_lshr_b32 s89, s9, 1
    s_lshl_b32 s89, s89, 15
    s_and_b32 s92, s9, 1
    s_lshl_b32 s92, s92, 8
    v_and_b32 v26, 15, v0
    v_lshrrev_b32 v27, 4, v0
    v_sub_u32 v28, v27, v26
    v_lshl_add_u32 v28, v28, 4, s89
    v_add_u32 v28, s92, v28
    v_add_u32 v56, 120304, v28
    s_add_u32 s89, s89, 102400
    s_lshr_b32 s92, s92, 1
    v_and_b32 v28, 4, v0
    v_lshl_add_u32 v28, v27, 3, v28
    v_and_b32 v27, 8, v0
    v_lshl_add_u32 v28, v27, 4, v28
    v_add_u32 v28, s92, v28
    v_and_b32 v26, 3, v0
    v_add_u32 v29, 4, v28
    v_lshrrev_b32 v27, 4, v29
    v_bfe_u32 v48, v29, 7, 1
    v_xor_b32 v48, v48, v27
    v_lshl_add_u32 v48, v48, 7, s89
    v_add_u32 v27, v27, v26
    v_and_b32 v27, 3, v27
    v_lshl_add_u32 v48, v27, 5, v48
    v_and_b32 v27, 15, v29
    v_lshl_add_u32 v48, v27, 1, v48
    v_xor_b32 v50, 64, v48
    v_and_b32 v29, 32, v29
    v_lshlrev_b32 v29, 2, v29
    v_xor_b32 v52, v50, v29
    v_add_u32 v29, 8, v28
    v_lshrrev_b32 v27, 4, v29
    v_bfe_u32 v49, v29, 7, 1
    v_xor_b32 v49, v49, v27
    v_lshl_add_u32 v49, v49, 7, s89
    v_add_u32 v27, v27, v26
    v_and_b32 v27, 3, v27
    v_lshl_add_u32 v49, v27, 5, v49
    v_and_b32 v27, 15, v29
    v_lshl_add_u32 v49, v27, 1, v49
    v_xor_b32 v51, 64, v49
    v_and_b32 v29, 32, v29
    v_lshlrev_b32 v29, 2, v29
    v_xor_b32 v53, v51, v29
    s_lshr_b32 s89, s9, 1
    s_lshl_b32 s89, s89, 15
    s_add_u32 s89, s89, 102400
    s_and_b32 s90, s9, 1
    s_mul_i32 s92, s90, 0xfffff000
    s_add_u32 s92, s92, s89
    v_add_u32 v108, s92, v9
    s_lshl_b32 s90, s90, 7
    s_add_u32 s90, s90, 17
    v_add_u32 v100, s90, v0
    v_lshrrev_b32 v102, 1, v100
    v_bfe_u32 v103, v100, 4, 1
    v_xor_b32 v103, v103, v102
    v_lshl_add_u32 v103, v103, 7, s89
    v_and_b32 v101, 1, v100
    v_lshl_add_u32 v103, v101, 4, v103
    v_and_b32 v101, 3, v102
    v_lshl_add_u32 v104, v101, 5, v103
    v_xor_b32 v106, 64, v104
    v_add_u32 v101, 1, v102
    v_and_b32 v101, 3, v101
    v_lshl_add_u32 v105, v101, 5, v103
    v_xor_b32 v107, 64, v105
    v_mov_b32 v88, 0
    v_mov_b32 v89, 0
    v_mov_b32 v90, 0
    v_mov_b32 v91, 0
    s_mov_b32 s56, s32
    s_mov_b32 s57, s33
    s_mov_b32 s58, 524288
    s_mov_b32 s59, 0x20000
    s_mov_b32 s52, s16
    s_mov_b32 s53, s17
    s_mov_b32 s54, 2097152
    s_mov_b32 s55, 0x20000
    v_and_b32 v26, 31, v0
    v_lshrrev_b32 v27, 5, v0
    v_lshlrev_b32 v28, 2, v27
    v_sub_u32 v28, v26, v28
    v_lshlrev_b32 v28, 4, v28
    v_add_u32 v19, 90688, v28
    s_mul_i32 s89, s9, 2064
    s_add_u32 s89, s89, 57536
    v_add_u32 v16, s89, v9
    v_and_b32 v26, 15, v0
    v_lshl_add_u32 v26, v27, 4, v26
    v_lshlrev_b32 v26, 4, v26
    v_and_b32 v28, 16, v0
    v_cmp_eq_u32 vcc, 0, v28
    v_add_u32 v17, 1024, v26
    v_add_u32 v18, 1536, v26
    v_mov_b32 v29, 2048
    v_cndmask_b32 v17, v29, v17, vcc
    v_cndmask_b32 v18, v29, v18, vcc
    v_add_u32 v17, s89, v17
    v_add_u32 v18, s89, v18
    v_lshl_add_u32 v20, v28, 9, v26
    s_lshl_b32 s89, s6, 2
    s_add_u32 s89, s89, s9
    s_lshl_b32 s79, s89, 14
    s_lshl_b32 s90, s76, 9
    s_add_u32 s79, s79, s90
    s_add_u32 s79, s79, 5242880
    s_lshl_b32 s80, s89, 4
    s_add_u32 s80, s80, s76
    s_lshl_b32 s80, s80, 2
    s_add_u32 s80, s80, 6492160
    s_mov_b32 s77, 0x2b800000
    s_mov_b32 s78, 0x53800000
    v_and_b32 v26, 0x30, v0
    v_lshlrev_b32 v26, 1, v26
    v_xor_b32 v32, v26, v8
    v_add_u32 v33, 7168, v32
    s_and_b32 s18, s5, 7
    s_lshl_b32 s18, s18, 7
    s_lshl_b32 s89, s9, 17
    s_add_u32 s18, s18, s89
    s_lshl_b32 s17, s9, 14
    s_add_u32 s17, s17, 98304
    s_lshr_b32 s16, s5, 3
    s_lshl_b32 s16, s16, 1
    s_lshl_b32 s89, s9, 10
    s_add_u32 s89, s89, 94208
    v_add_u32 v34, s89, v9
    s_lshr_b32 s89, s9, 1
    s_lshl_b32 s90, s89, 15
    s_add_u32 s90, s90, 98304
    v_add_u32 v36, s90, v9
    s_lshl_b32 s20, s5, 1
    s_add_u32 s20, s20, s89
    s_lshl_b32 s20, s20, 11
    s_and_b32 s89, s9, 1
    s_lshl_b32 s89, s89, 21
    s_add_u32 s20, s20, s89
    s_lshl_b32 s89, s4, 7
    s_add_u32 s20, s20, s89
    v_lshlrev_b32 v28, 4, v31
    v_and_b32 v26, 16, v0
    v_lshl_add_u32 v35, v26, 15, v28
    v_and_b32 v26, 32, v0
    v_lshl_add_u32 v35, v26, 13, v35
    v_and_b32 v26, 8, v0
    v_lshl_add_u32 v35, v26, 14, v35
    s_lshl_b32 s19, s5, 2
    s_add_u32 s19, s19, s9
    s_lshl_b32 s19, s19, 15
    s_add_u32 s19, s19, s89
    v_lshrrev_b32 v29, 3, v0
    v_lshl_add_u32 v60, v29, 12, v28
    v_lshl_add_u32 v37, v29, 11, v28
    v_mul_u32_u24 v57, 1040, v31
    v_lshl_add_u32 v57, v29, 2, v57
    s_lshl_b32 s89, s9, 5
    s_add_u32 s89, s89, 82304
    v_add_u32 v57, s89, v57
    s_mul_i32 s89, s9, 2080
    s_add_u32 s89, s89, 82304
    v_add_u32 v38, s89, v9
    s_lshr_b32 s89, s93, 5
    s_lshl_b32 s89, s89, 8
    s_and_b32 s90, s93, 31
    s_lshl_b32 s90, s90, 2
    s_add_u32 s21, s89, s90
    s_add_u32 s21, s21, 6422528
    s_lshl_b32 s92, s4, 2
    s_add_u32 s92, s92, s9
    s_lshl_b32 s92, s92, 8
    s_add_u32 s92, s92, 6422528
    s_lshl_b32 s89, s93, 10
    s_add_u32 s89, s89, 4194304
    v_lshl_add_u32 v39, v31, 7, s89
    v_and_b32 v26, 8, v0
    v_lshl_add_u32 v39, v26, 17, v39
    s_sub_u32 s89, s80, 4096
    v_writelane_b32 v39, s80, 16
    v_writelane_b32 v39, s89, 17
    v_writelane_b32 v39, s92, 18
    s_lshl_b32 s89, s9, 3
    s_add_u32 s89, s89, 93696
    v_mov_b32 v40, s89
    s_and_b32 s89, s9, 2
    s_lshl_b32 s89, s89, 3
    s_waitcnt lgkmcnt(0)
    s_lshr_b32 s91, s91, s89
    s_lshl_b32 s91, s91, 16
    ds_write_b128 v108, v[88:91]
    ds_write_b128 v108, v[88:91] offset:256
    s_bitcmp1_b32 s9, 0
    s_cselect_b64 s[64:65], s[64:65], 0
    s_waitcnt vmcnt(12)
    v_lshlrev_b32 v92, 16, v64
    v_add_f32 v92, s91, v92
    v_and_b32 v93, 0xffff0000, v64
    v_cvt_pk_bf16_f32 v92, v92, v93
    v_cmp_eq_u32 vcc, 17, v100
    s_nop 1
    v_cndmask_b32 v64, v64, v92, vcc
    v_mov_b32 v72, s64
    v_mov_b32 v76, s65
    v_mov_b32 v77, v64
    v_mov_b32 v78, v65
    v_mov_b32_dpp v72, v66 wave_shr:1 row_mask:0xf bank_mask:0xf
    v_mov_b32_dpp v76, v67 wave_shr:1 row_mask:0xf bank_mask:0xf
    v_mov_b32 v79, v66
    v_alignbit_b32 v80, v76, v72, 16
    v_alignbit_b32 v81, v64, v76, 16
    v_alignbit_b32 v82, v65, v64, 16
    v_alignbit_b32 v83, v66, v65, 16
    v_mov_b32 v84, v81
    v_mov_b32 v85, v82
    v_mov_b32 v86, v83
    v_alignbit_b32 v87, v67, v66, 16
    ds_write_b128 v107, v[64:67] offset:0
    ds_write_b128 v105, v[76:79] offset:0
    ds_write_b128 v104, v[80:83] offset:0
    ds_write_b128 v106, v[84:87] offset:0
    v_readlane_b32 s64, v66, 63
    v_readlane_b32 s65, v67, 63
    s_waitcnt lgkmcnt(0)
    s_nop 0
    v_mov_b32 v72, s64
    v_mov_b32 v76, s65
    v_mov_b32 v77, v68
    v_mov_b32 v78, v69
    v_mov_b32_dpp v72, v70 wave_shr:1 row_mask:0xf bank_mask:0xf
    v_mov_b32_dpp v76, v71 wave_shr:1 row_mask:0xf bank_mask:0xf
    v_mov_b32 v79, v70
    v_alignbit_b32 v80, v76, v72, 16
    v_alignbit_b32 v81, v68, v76, 16
    v_alignbit_b32 v82, v69, v68, 16
    v_alignbit_b32 v83, v70, v69, 16
    v_mov_b32 v84, v81
    v_mov_b32 v85, v82
    v_mov_b32 v86, v83
    v_alignbit_b32 v87, v71, v70, 16
    ds_write_b128 v107, v[68:71] offset:4096
    ds_write_b128 v105, v[76:79] offset:4096
    ds_write_b128 v104, v[80:83] offset:4096
    ds_write_b128 v106, v[84:87] offset:4096
    s_waitcnt vmcnt(6) lgkmcnt(0)
    s_barrier
    v_and_b32 v26, 3, v0
    v_mul_u32_u24 v27, 3072, v26
    v_and_b32 v28, 12, v0
    v_lshl_add_u32 v27, v28, 8, v27
    v_lshlrev_b32 v26, 10, v26
    s_lshl_b32 s11, s5, 2
    s_add_u32 s11, s11, s9
    s_mul_i32 s12, s11, 12288
    s_lshl_b32 s11, s11, 12
    s_mov_b64 exec, 0xfff
    buffer_load_dword v22, v27, s[48:51], s12 offen offset:384
    s_mov_b64 exec, 0xf
    buffer_load_dword v22, v26, s[56:59], s11 offen offset:384
    s_mov_b64 exec, -1
    s_add_u32 m0, s67, 16384
    s_add_u32 s11, s8, 1
    s_and_b32 s11, s11, 7
    s_lshl_b32 s85, s11, 7
    s_add_u32 s85, s85, s83
    s_mul_i32 s86, s11, 196608
    s_add_u32 s86, s86, s84
    buffer_load_dwordx4 v2, s[44:47], s85 offen offset:0 lds
    buffer_load_dwordx4 v3, s[44:47], s85 offen offset:1024 lds
    buffer_load_dwordx4 v4, s[44:47], s85 offen offset:2048 lds
    buffer_load_dwordx4 v5, s[44:47], s85 offen offset:3072 lds
    s_add_u32 m0, s81, 81920
    s_nop 0
    buffer_load_dwordx4 v6, s[48:51], s86 offen offset:0 lds
    buffer_load_dwordx4 v7, s[48:51], s86 offen offset:1024 lds
    s_add_u32 m0, s67, 32768
    s_add_u32 s11, s8, 2
    s_and_b32 s11, s11, 7
    s_lshl_b32 s85, s11, 7
    s_add_u32 s85, s85, s83
    s_mul_i32 s86, s11, 196608
    s_add_u32 s86, s86, s84
    buffer_load_dwordx4 v2, s[44:47], s85 offen offset:0 lds
    buffer_load_dwordx4 v3, s[44:47], s85 offen offset:1024 lds
    s_waitcnt vmcnt(10)
    s_barrier
    buffer_load_dwordx4 v4, s[44:47], s85 offen offset:2048 lds
    buffer_load_dwordx4 v5, s[44:47], s85 offen offset:3072 lds
    s_add_u32 m0, s81, 73728
    s_nop 0
    buffer_load_dwordx4 v6, s[48:51], s86 offen offset:0 lds
    buffer_load_dwordx4 v7, s[48:51], s86 offen offset:1024 lds
    s_add_u32 m0, s67, 49152
    s_add_u32 s11, s8, 3
    s_and_b32 s11, s11, 7
    s_lshl_b32 s85, s11, 7
    s_add_u32 s85, s85, s83
    s_mul_i32 s86, s11, 196608
    s_add_u32 s86, s86, s84
    buffer_load_dwordx4 v2, s[44:47], s85 offen offset:0 lds
    buffer_load_dwordx4 v3, s[44:47], s85 offen offset:1024 lds
    buffer_load_dwordx4 v4, s[44:47], s85 offen offset:2048 lds
    buffer_load_dwordx4 v5, s[44:47], s85 offen offset:3072 lds
    s_waitcnt vmcnt(10)
    s_barrier
    s_add_u32 m0, s81, 65536
    s_nop 0
    buffer_load_dwordx4 v6, s[48:51], s86 offen offset:0 lds
    buffer_load_dwordx4 v7, s[48:51], s86 offen offset:1024 lds
    s_add_u32 m0, s67, 0
    s_add_u32 s11, s8, 4
    s_and_b32 s11, s11, 7
    s_lshl_b32 s85, s11, 7
    s_add_u32 s85, s85, s83
    s_mul_i32 s86, s11, 196608
    s_add_u32 s86, s86, s84
    buffer_load_dwordx4 v2, s[44:47], s85 offen offset:0 lds
    buffer_load_dwordx4 v3, s[44:47], s85 offen offset:1024 lds
    buffer_load_dwordx4 v4, s[44:47], s85 offen offset:2048 lds
    buffer_load_dwordx4 v5, s[44:47], s85 offen offset:3072 lds
    s_waitcnt vmcnt(10)
    s_barrier
    s_add_u32 m0, s81, 90112
    s_nop 0
    buffer_load_dwordx4 v6, s[48:51], s86 offen offset:0 lds
    buffer_load_dwordx4 v7, s[48:51], s86 offen offset:1024 lds
    s_mul_i32 s82, s9, 49152
    s_lshl_b32 s11, s76, 6
    s_add_u32 s82, s82, s11
    s_lshl_b32 s87, s9, 10
    s_add_u32 s11, s8, 0
    s_and_b32 s11, s11, 7
    s_mul_i32 s11, s11, 196608
    s_add_u32 m0, s87, 98304
    s_add_u32 s11, s11, s82
    buffer_load_dwordx4 v10, s[48:51], s11 offen lds
    s_add_u32 s11, s8, 2
    s_and_b32 s11, s11, 7
    s_mul_i32 s11, s11, 196608
    s_add_u32 m0, s87, 131072
    s_add_u32 s11, s11, s82
    buffer_load_dwordx4 v10, s[48:51], s11 offen lds
    s_add_u32 m0, s67, 16384
    s_add_u32 s11, s8, 5
    s_and_b32 s11, s11, 7
    s_lshl_b32 s85, s11, 7
    s_add_u32 s85, s85, s83
    s_mul_i32 s86, s11, 196608
    s_add_u32 s86, s86, s84
    buffer_load_dwordx4 v2, s[44:47], s85 offen offset:0 lds
    buffer_load_dwordx4 v3, s[44:47], s85 offen offset:1024 lds
    s_waitcnt vmcnt(10)
    s_barrier
    buffer_load_dwordx4 v4, s[44:47], s85 offen offset:2048 lds
    buffer_load_dwordx4 v5, s[44:47], s85 offen offset:3072 lds
    s_add_u32 m0, s81, 81920
    s_nop 0
    buffer_load_dwordx4 v6, s[48:51], s86 offen offset:0 lds
    buffer_load_dwordx4 v7, s[48:51], s86 offen offset:1024 lds
    s_add_u32 m0, s67, 32768
    s_add_u32 s11, s8, 6
    s_and_b32 s11, s11, 7
    s_lshl_b32 s85, s11, 7
    s_add_u32 s85, s85, s83
    s_mul_i32 s86, s11, 196608
    s_add_u32 s86, s86, s84
    buffer_load_dwordx4 v2, s[44:47], s85 offen offset:0 lds
    buffer_load_dwordx4 v3, s[44:47], s85 offen offset:1024 lds
    s_waitcnt vmcnt(10)
    s_barrier
    buffer_load_dwordx4 v4, s[44:47], s85 offen offset:2048 lds
    buffer_load_dwordx4 v5, s[44:47], s85 offen offset:3072 lds
    s_add_u32 m0, s81, 73728
    s_nop 0
    buffer_load_dwordx4 v6, s[48:51], s86 offen offset:0 lds
    buffer_load_dwordx4 v7, s[48:51], s86 offen offset:1024 lds
    s_add_u32 m0, s67, 49152
    s_add_u32 s11, s8, 7
    s_and_b32 s11, s11, 7
    s_lshl_b32 s85, s11, 7
    s_add_u32 s85, s85, s83
    s_mul_i32 s86, s11, 196608
    s_add_u32 s86, s86, s84
    buffer_load_dwordx4 v2, s[44:47], s85 offen offset:0 lds
    buffer_load_dwordx4 v3, s[44:47], s85 offen offset:1024 lds
    buffer_load_dwordx4 v4, s[44:47], s85 offen offset:2048 lds
    buffer_load_dwordx4 v5, s[44:47], s85 offen offset:3072 lds
    s_waitcnt vmcnt(10)
    s_barrier
    ds_write_b32 v24, v88
    ds_write_b32 v59, v88
    ds_write_b128 v36, v[88:91] offset:25856
    s_add_u32 m0, s81, 65536
    s_nop 0
    buffer_load_dwordx4 v6, s[48:51], s86 offen offset:0 lds
    buffer_load_dwordx4 v7, s[48:51], s86 offen offset:1024 lds
    s_add_u32 s11, s8, 1
    s_and_b32 s11, s11, 7
    s_mul_i32 s11, s11, 196608
    s_add_u32 m0, s87, 4096
    s_add_u32 s11, s11, s82
    buffer_load_dwordx4 v10, s[48:51], s11 offen lds
    s_add_u32 s11, s8, 3
    s_and_b32 s11, s11, 7
    s_mul_i32 s11, s11, 196608
    s_add_u32 m0, s87, 12288
    s_add_u32 s11, s11, s82
    buffer_load_dwordx4 v10, s[48:51], s11 offen lds
    s_waitcnt vmcnt(8) lgkmcnt(0)
    s_barrier
    s_add_u32 s11, s8, 4
    s_and_b32 s11, s11, 7
    s_mul_i32 s11, s11, 196608
    s_add_u32 m0, s87, 16384
    s_add_u32 s11, s11, s82
    buffer_load_dwordx4 v10, s[48:51], s11 offen lds
    s_add_u32 s11, s8, 5
    s_and_b32 s11, s11, 7
    s_mul_i32 s11, s11, 196608
    s_add_u32 m0, s87, 20480
    s_add_u32 s11, s11, s82
    buffer_load_dwordx4 v10, s[48:51], s11 offen lds
    s_waitcnt vmcnt(4)
    s_barrier
    s_add_u32 s11, s8, 6
    s_and_b32 s11, s11, 7
    s_mul_i32 s11, s11, 196608
    s_add_u32 m0, s87, 24576
    s_add_u32 s11, s11, s82
    buffer_load_dwordx4 v10, s[48:51], s11 offen lds
    s_add_u32 s11, s8, 7
    s_and_b32 s11, s11, 7
    s_mul_i32 s11, s11, 196608
    s_add_u32 m0, s87, 28672
    s_add_u32 s11, s11, s82
    buffer_load_dwordx4 v10, s[48:51], s11 offen lds
    s_branch L_arole
L_brole:
    s_waitcnt lgkmcnt(0)
    s_mov_b32 s40, s38
    s_mov_b32 s41, s39
    s_mov_b32 s42, 8388608
    s_mov_b32 s43, 0x20000
    s_mov_b32 s60, s34
    s_mov_b32 s61, s35
    s_mov_b32 s62, 4194304
    s_mov_b32 s63, 0x20000
    v_lshrrev_b32 v29, 3, v0
    v_and_b32 v28, 7, v0
    v_lshlrev_b32 v28, 4, v28
    v_lshl_add_u32 v51, v29, 11, v28
    v_lshl_add_u32 v50, v29, 10, v28
    s_lshl_b32 s11, s4, 2
    s_add_u32 s11, s11, s9
    s_lshl_b32 s92, s11, 6
    s_add_u32 s92, s92, s5
    s_lshl_b32 s92, s92, 2
    s_add_u32 s92, s92, 6356992
    v_xor_b32 v26, 0x70, v28
    v_lshl_add_u32 v61, v29, 12, v26
    s_lshl_b32 s91, s5, 2
    s_add_u32 s91, s91, s9
    s_lshl_b32 s91, s91, 15
    s_lshl_b32 s12, s4, 7
    s_add_u32 s91, s91, s12
    v_xor_b32 v26, 7, v29
    v_lshl_add_u32 v52, v26, 17, v28
    v_mul_u32_u24 v57, 65, v28
    v_lshl_add_u32 v57, v29, 2, v57
    s_lshl_b32 s12, s9, 5
    v_add_u32 v57, s12, v57
    v_and_b32 v26, 31, v0
    v_lshrrev_b32 v27, 5, v0
    v_bfe_u32 v28, v0, 1, 3
    v_xor_b32 v28, v28, v27
    v_lshlrev_b32 v28, 4, v28
    v_lshl_add_u32 v28, v26, 7, v28
    s_lshl_b32 s12, s9, 12
    v_add_u32 v2, s12, v28
    v_xor_b32 v3, 32, v2
    v_xor_b32 v4, 64, v2
    v_xor_b32 v5, 0x60, v2
    v_bfe_u32 v26, v0, 2, 2
    v_lshl_add_u32 v28, v27, 3, v26
    v_and_b32 v8, 3, v0
    v_lshlrev_b32 v8, 3, v8
    v_bfe_u32 v6, v0, 4, 1
    v_lshl_add_u32 v8, v6, 5, v8
    v_lshl_add_u32 v6, v28, 7, v8
    v_lshrrev_b32 v26, 1, v26
    v_lshl_add_u32 v6, v26, 6, v6
    v_add_u32 v6, 65536, v6
    v_xor_b32 v7, 64, v6
    v_lshl_add_u32 v8, v28, 6, v8
    v_add_u32 v10, 98304, v8
    v_and_b32 v26, 15, v0
    v_lshl_add_u32 v26, v27, 4, v26
    v_and_b32 v28, 16, v0
    v_lshl_add_u32 v26, v28, 1, v26
    v_lshlrev_b32 v26, 4, v26
    v_add_u32 v11, 1024, v26
    s_lshl_b32 s11, s6, 2
    s_add_u32 s11, s11, s9
    s_and_b32 s12, s7, 7
    s_lshl_b32 s83, s12, 8
    s_add_u32 s83, s83, s11
    s_lshl_b32 s83, s83, 11
    s_lshl_b32 s84, s12, 6
    s_add_u32 s84, s84, s11
    s_lshl_b32 s84, s84, 1
    s_lshr_b32 s12, s7, 3
    s_add_u32 s84, s84, s12
    s_mul_i32 s84, s84, 32
    s_add_u32 s84, s84, 6291456
    s_lshr_b32 s85, s76, 1
    s_mul_i32 s85, s85, 4096
    s_add_u32 s85, s85, 6291456
    s_mov_b32 s89, 0x3eb8aa3b
    v_lshlrev_b32 v9, 4, v0
    s_lshl_b32 s11, s3, 7
    s_add_u32 s11, s11, 92672
    v_and_b32 v29, 31, v0
    v_lshl_add_u32 v24, v29, 2, s11
    v_and_b32 v27, 3, v0
    v_lshlrev_b32 v27, 7, v27
    v_lshl_add_u32 v29, v29, 2, v27
    v_add_u32 v25, 92672, v29
    v_add_u32 v30, 93184, v29
    s_mov_b32 s56, s32
    s_mov_b32 s57, s33
    s_mov_b32 s58, 524288
    s_mov_b32 s59, 0x20000
    v_and_b32 v26, 31, v0
    v_lshrrev_b32 v27, 5, v0
    v_lshlrev_b32 v28, 2, v27
    v_sub_u32 v28, v26, v28
    v_lshlrev_b32 v28, 4, v28
    v_add_u32 v19, 90688, v28
    s_mul_i32 s11, s9, 2064
    s_add_u32 s11, s11, 32768
    v_add_u32 v16, s11, v9
    v_and_b32 v26, 15, v0
    v_lshl_add_u32 v26, v27, 4, v26
    v_lshlrev_b32 v26, 4, v26
    v_and_b32 v28, 16, v0
    v_cmp_eq_u32 vcc, 0, v28
    v_add_u32 v17, 1024, v26
    v_add_u32 v18, 1536, v26
    v_mov_b32 v29, 2048
    v_cndmask_b32 v17, v29, v17, vcc
    v_cndmask_b32 v18, v29, v18, vcc
    v_add_u32 v17, s11, v17
    v_add_u32 v18, s11, v18
    v_lshl_add_u32 v20, v28, 9, v26
    s_lshl_b32 s11, s6, 2
    s_add_u32 s11, s11, s9
    s_lshl_b32 s79, s11, 14
    s_lshl_b32 s12, s76, 9
    s_add_u32 s79, s79, s12
    s_add_u32 s79, s79, 4194304
    s_lshl_b32 s80, s11, 4
    s_add_u32 s80, s80, s76
    s_lshl_b32 s80, s80, 2
    s_add_u32 s80, s80, 6488064
    s_mov_b32 s77, 0x2b800000
    s_mov_b32 s78, 0x53800000
    s_and_b32 s11, s9, 2
    s_mul_i32 s11, s11, 0
    s_add_u32 s11, s11, s9
    s_add_u32 s11, s11, 4
    s_mul_i32 s16, s11, 2064
    s_add_u32 s16, s16, 32768
    s_lshl_b32 s12, s6, 2
    s_add_u32 s11, s11, s12
    s_lshl_b32 s12, s76, 7
    s_add_u32 s12, s12, s11
    s_add_u32 s12, s12, 0xfffffff8
    s_lshl_b32 s12, s12, 11
    s_cmp_lt_u32 s11, 8
    s_cselect_b32 s17, 0x10000000, s12
    s_and_b32 s11, s9, 2
    s_mul_i32 s11, s11, 2
    s_add_u32 s11, s11, s9
    s_add_u32 s11, s11, 2
    s_mul_i32 s18, s11, 2064
    s_add_u32 s18, s18, 32768
    s_lshl_b32 s12, s6, 2
    s_add_u32 s11, s11, s12
    s_lshl_b32 s12, s76, 7
    s_add_u32 s12, s12, s11
    s_add_u32 s12, s12, 0xfffffff8
    s_lshl_b32 s12, s12, 11
    s_cmp_lt_u32 s11, 8
    s_cselect_b32 s19, 0x10000000, s12
    s_and_b32 s11, s9, 2
    s_mul_i32 s11, s11, 4
    s_add_u32 s11, s11, s9
    s_add_u32 s11, s11, 0
    s_mul_i32 s20, s11, 2064
    s_add_u32 s20, s20, 32768
    s_lshl_b32 s12, s6, 2
    s_add_u32 s11, s11, s12
    s_lshl_b32 s12, s76, 7
    s_add_u32 s12, s12, s11
    s_add_u32 s12, s12, 0xfffffff8
    s_lshl_b32 s12, s12, 11
    s_cmp_lt_u32 s11, 8
    s_cselect_b32 s21, 0x10000000, s12
    v_and_b32 v26, 0x30, v0
    v_lshlrev_b32 v26, 1, v26
    v_xor_b32 v48, v26, v50
    v_add_u32 v49, 7168, v48
    s_and_b32 s24, s5, 7
    s_lshl_b32 s24, s24, 7
    s_lshl_b32 s11, s9, 17
    s_add_u32 s24, s24, s11
    s_lshl_b32 s23, s9, 14
    s_add_u32 s23, s23, 98304
    s_lshr_b32 s22, s5, 3
    s_lshl_b32 s22, s22, 1
    s_lshr_b32 s11, s9, 1
    s_lshl_b32 s26, s5, 1
    s_add_u32 s26, s26, s11
    s_lshl_b32 s26, s26, 11
    s_lshl_b32 s12, s4, 7
    s_add_u32 s26, s26, s12
    s_andn2_b32 s13, 1, s9
    s_lshl_b32 s13, s13, 21
    s_add_u32 s26, s26, s13
    s_add_u32 s25, s26, 0x100000
    s_mul_i32 s11, s11, 28672
    s_lshl_b32 s90, s9, 11
    s_add_u32 s90, s90, s11
    s_lshl_b32 s11, s4, 2
    s_lshr_b32 s12, s5, 3
    s_add_u32 s11, s11, s12
    s_lshl_b32 s93, s11, 8
    s_add_u32 s93, s93, 6356992
    s_lshl_b32 s11, s11, 2
    s_add_u32 s11, s11, s9
    s_lshl_b32 s87, s11, 13
    s_add_u32 s87, s87, 4194304
    s_lshr_b32 s11, s11, 1
    s_lshl_b32 s88, s11, 6
    s_add_u32 s88, s88, 6488064
    s_lshl_b32 s12, s6, 3
    s_sub_u32 s12, s12, 16
    v_min_u32 v28, 23, v0
    v_add_u32 v56, s12, v28
    v_max_i32 v56, 0, v56
    v_mul_u32_u24 v56, 32, v56
    v_cmp_gt_u32 vcc, 12, v28
    v_subrev_u32 v26, 12, v28
    s_lshl_b32 s11, s6, 2
    v_cndmask_b32 v26, v26, v28, vcc
    v_add_u32 v26, s11, v26
    v_cmp_le_u32 vcc, 8, v26
    v_mov_b32 v27, 0x3f803f80
    v_mul_u32_u24 v28, 2064, v28
    v_cndmask_b32 v59, 0, v27, vcc
    v_add_u32 v58, 34816, v28
    v_add_u32 v26, 120064, v57
    v_add_u32 v27, 121104, v57
    v_add_u32 v28, 152832, v57
    s_lshl_b32 s12, s9, 7
    s_add_u32 s12, s12, 161280
    v_and_b32 v29, 0x38, v0
    v_lshl_add_u32 v29, v29, 1, s12
    s_barrier
    ds_read_b128 v[40:43], v29
    ds_read2_b32 v[128:129], v26 offset0:128 offset1:160
    ds_read2_b32 v[130:131], v26 offset0:192 offset1:224
    ds_read2_b32 v[132:133], v27 offset0:0 offset1:32
    ds_read2_b32 v[134:135], v27 offset0:64 offset1:96
    ds_read2_b32 v[136:137], v27 offset0:128 offset1:160
    ds_read2_b32 v[138:139], v27 offset0:192 offset1:224
    ds_read2_b32 v[140:141], v28 offset0:0 offset1:32
    ds_read2_b32 v[142:143], v28 offset0:64 offset1:96
    ds_read2_b32 v[144:145], v28 offset0:128 offset1:160
    ds_read2_b32 v[146:147], v28 offset0:192 offset1:224
    s_waitcnt lgkmcnt(10)
    v_lshlrev_b32 v32, 16, v40
    v_lshlrev_b32 v33, 16, v42
    v_and_b32 v34, 0xffff0000, v40
    v_and_b32 v35, 0xffff0000, v42
    v_lshlrev_b32 v36, 16, v41
    v_lshlrev_b32 v37, 16, v43
    v_and_b32 v38, 0xffff0000, v41
    v_and_b32 v39, 0xffff0000, v43
    s_waitcnt lgkmcnt(4)
    v_lshlrev_b32 v150, 16, v129
    v_and_b32 v151, 0xffff0000, v129
    v_lshlrev_b32 v152, 16, v130
    v_and_b32 v153, 0xffff0000, v130
    v_lshlrev_b32 v154, 16, v131
    v_and_b32 v155, 0xffff0000, v131
    v_lshlrev_b32 v156, 16, v132
    v_and_b32 v157, 0xffff0000, v132
    v_lshlrev_b32 v158, 16, v133
    v_and_b32 v159, 0xffff0000, v133
    v_lshlrev_b32 v160, 16, v134
    v_and_b32 v161, 0xffff0000, v134
    v_lshlrev_b32 v162, 16, v135
    v_and_b32 v163, 0xffff0000, v135
    v_lshlrev_b32 v164, 16, v136
    v_and_b32 v165, 0xffff0000, v136
    v_lshlrev_b32 v166, 16, v137
    v_and_b32 v167, 0xffff0000, v137
    v_lshlrev_b32 v168, 16, v138
    v_and_b32 v169, 0xffff0000, v138
    v_lshlrev_b32 v170, 16, v139
    v_and_b32 v171, 0xffff0000, v139
    v_pk_mul_f32 v[172:173], v[32:33], v[156:157]
    v_pk_mul_f32 v[174:175], v[32:33], v[158:159]
    v_pk_mul_f32 v[176:177], v[32:33], v[160:161]
    v_pk_mul_f32 v[178:179], v[32:33], v[162:163]
    v_pk_mul_f32 v[180:181], v[32:33], v[164:165]
    v_pk_mul_f32 v[182:183], v[32:33], v[166:167]
    v_pk_mul_f32 v[184:185], v[32:33], v[168:169]
    v_pk_mul_f32 v[186:187], v[32:33], v[170:171]
    v_pk_fma_f32 v[172:173], v[34:35], v[154:155], v[172:173]
    v_pk_fma_f32 v[174:175], v[34:35], v[156:157], v[174:175]
    v_pk_fma_f32 v[176:177], v[34:35], v[158:159], v[176:177]
    v_pk_fma_f32 v[178:179], v[34:35], v[160:161], v[178:179]
    v_pk_fma_f32 v[180:181], v[34:35], v[162:163], v[180:181]
    v_pk_fma_f32 v[182:183], v[34:35], v[164:165], v[182:183]
    v_pk_fma_f32 v[184:185], v[34:35], v[166:167], v[184:185]
    v_pk_fma_f32 v[186:187], v[34:35], v[168:169], v[186:187]
    v_pk_fma_f32 v[172:173], v[36:37], v[152:153], v[172:173]
    v_pk_fma_f32 v[174:175], v[36:37], v[154:155], v[174:175]
    v_pk_fma_f32 v[176:177], v[36:37], v[156:157], v[176:177]
    v_pk_fma_f32 v[178:179], v[36:37], v[158:159], v[178:179]
    v_pk_fma_f32 v[180:181], v[36:37], v[160:161], v[180:181]
    v_pk_fma_f32 v[182:183], v[36:37], v[162:163], v[182:183]
    v_pk_fma_f32 v[184:185], v[36:37], v[164:165], v[184:185]
    v_pk_fma_f32 v[186:187], v[36:37], v[166:167], v[186:187]
    v_pk_fma_f32 v[172:173], v[38:39], v[150:151], v[172:173]
    v_pk_fma_f32 v[174:175], v[38:39], v[152:153], v[174:175]
    v_pk_fma_f32 v[176:177], v[38:39], v[154:155], v[176:177]
    v_pk_fma_f32 v[178:179], v[38:39], v[156:157], v[178:179]
    v_pk_fma_f32 v[180:181], v[38:39], v[158:159], v[180:181]
    v_pk_fma_f32 v[182:183], v[38:39], v[160:161], v[182:183]
    v_pk_fma_f32 v[184:185], v[38:39], v[162:163], v[184:185]
    v_pk_fma_f32 v[186:187], v[38:39], v[164:165], v[186:187]
    s_waitcnt lgkmcnt(0)
    v_lshlrev_b32 v188, 16, v140
    v_and_b32 v189, 0xffff0000, v140
    v_pk_mul_f32 v[172:173], v[172:173], v[188:189]
    v_lshlrev_b32 v190, 16, v141
    v_and_b32 v191, 0xffff0000, v141
    v_pk_mul_f32 v[174:175], v[174:175], v[190:191]
    v_lshlrev_b32 v188, 16, v142
    v_and_b32 v189, 0xffff0000, v142
    v_pk_mul_f32 v[176:177], v[176:177], v[188:189]
    v_lshlrev_b32 v190, 16, v143
    v_and_b32 v191, 0xffff0000, v143
    v_pk_mul_f32 v[178:179], v[178:179], v[190:191]
    v_lshlrev_b32 v188, 16, v144
    v_and_b32 v189, 0xffff0000, v144
    v_pk_mul_f32 v[180:181], v[180:181], v[188:189]
    v_lshlrev_b32 v190, 16, v145
    v_and_b32 v191, 0xffff0000, v145
    v_pk_mul_f32 v[182:183], v[182:183], v[190:191]
    v_lshlrev_b32 v188, 16, v146
    v_and_b32 v189, 0xffff0000, v146
    v_pk_mul_f32 v[184:185], v[184:185], v[188:189]
    v_lshlrev_b32 v190, 16, v147
    v_and_b32 v191, 0xffff0000, v147
    v_pk_mul_f32 v[186:187], v[186:187], v[190:191]
    v_cvt_pk_bf16_f32 v40, v186, v184
    v_cvt_pk_bf16_f32 v41, v182, v180
    v_cvt_pk_bf16_f32 v42, v178, v176
    v_cvt_pk_bf16_f32 v43, v174, v172
    v_cvt_pk_bf16_f32 v44, v187, v185
    v_cvt_pk_bf16_f32 v45, v183, v181
    v_cvt_pk_bf16_f32 v46, v179, v177
    v_cvt_pk_bf16_f32 v47, v175, v173
    buffer_store_dwordx4 v[40:43], v61, s[60:63], s91 offen
    buffer_store_dwordx4 v[44:47], v61, s[60:63], s91 offen offset:2048
    v_mov_b32 v22, 0
    global_load_dword v21, v22, s[36:37] sc1
    s_cmp_ge_u32 s7, 8
    s_cbranch_scc1 L_vgemm
    s_barrier
    ds_read_b128 v[128:131], v2 offset:0
    ds_read_b64_tr_b16 v[64:65], v6 offset:24576
    ds_read_b64_tr_b16 v[66:67], v6 offset:25088
    ds_read_b64_tr_b16 v[68:69], v7 offset:24576
    ds_read_b64_tr_b16 v[70:71], v7 offset:25088
    ds_read_b128 v[132:135], v3 offset:0
    ds_read_b64_tr_b16 v[72:73], v6 offset:26624
    ds_read_b64_tr_b16 v[74:75], v6 offset:27136
    ds_read_b64_tr_b16 v[76:77], v7 offset:26624
    ds_read_b64_tr_b16 v[78:79], v7 offset:27136
    ds_read_b128 v[136:139], v4 offset:0
    ds_read_b64_tr_b16 v[80:81], v6 offset:28672
    ds_read_b64_tr_b16 v[82:83], v6 offset:29184
    ds_read_b64_tr_b16 v[84:85], v7 offset:28672
    ds_read_b64_tr_b16 v[86:87], v7 offset:29184
    s_waitcnt lgkmcnt(12)
    v_mfma_f32_32x32x16_bf16 v[96:111], v[64:67], v[128:131], 0
    s_waitcnt lgkmcnt(10)
    v_mfma_f32_32x32x16_bf16 v[112:127], v[68:71], v[128:131], 0
    ds_read_b128 v[140:143], v5 offset:0
    ds_read_b64_tr_b16 v[88:89], v6 offset:30720
    ds_read_b64_tr_b16 v[90:91], v6 offset:31232
    ds_read_b64_tr_b16 v[92:93], v7 offset:30720
    ds_read_b64_tr_b16 v[94:95], v7 offset:31232
    s_waitcnt lgkmcnt(12)
    v_mfma_f32_32x32x16_bf16 v[96:111], v[72:75], v[132:135], v[96:111]
    s_waitcnt lgkmcnt(10)
    v_mfma_f32_32x32x16_bf16 v[112:127], v[76:79], v[132:135], v[112:127]
    s_waitcnt lgkmcnt(7)
    v_mfma_f32_32x32x16_bf16 v[96:111], v[80:83], v[136:139], v[96:111]
    s_waitcnt lgkmcnt(5)
    v_mfma_f32_32x32x16_bf16 v[112:127], v[84:87], v[136:139], v[112:127]
    s_waitcnt lgkmcnt(2)
    v_mfma_f32_32x32x16_bf16 v[96:111], v[88:91], v[140:143], v[96:111]
    s_waitcnt lgkmcnt(0)
    v_mfma_f32_32x32x16_bf16 v[112:127], v[92:95], v[140:143], v[112:127]
    s_barrier
    ds_read_b128 v[144:147], v2 offset:16384
    ds_read_b64_tr_b16 v[64:65], v6 offset:16384
    ds_read_b64_tr_b16 v[66:67], v6 offset:16896
    ds_read_b64_tr_b16 v[68:69], v7 offset:16384
    ds_read_b64_tr_b16 v[70:71], v7 offset:16896
    ds_read_b128 v[148:151], v3 offset:16384
    ds_read_b64_tr_b16 v[72:73], v6 offset:18432
    ds_read_b64_tr_b16 v[74:75], v6 offset:18944
    ds_read_b64_tr_b16 v[76:77], v7 offset:18432
    ds_read_b64_tr_b16 v[78:79], v7 offset:18944
    ds_read_b128 v[152:155], v4 offset:16384
    ds_read_b64_tr_b16 v[80:81], v6 offset:20480
    ds_read_b64_tr_b16 v[82:83], v6 offset:20992
    ds_read_b64_tr_b16 v[84:85], v7 offset:20480
    ds_read_b64_tr_b16 v[86:87], v7 offset:20992
    s_waitcnt lgkmcnt(12)
    v_mfma_f32_32x32x16_bf16 v[96:111], v[64:67], v[144:147], v[96:111]
    s_waitcnt lgkmcnt(10)
    v_mfma_f32_32x32x16_bf16 v[112:127], v[68:71], v[144:147], v[112:127]
    ds_read_b128 v[156:159], v5 offset:16384
    ds_read_b64_tr_b16 v[88:89], v6 offset:22528
    ds_read_b64_tr_b16 v[90:91], v6 offset:23040
    ds_read_b64_tr_b16 v[92:93], v7 offset:22528
    ds_read_b64_tr_b16 v[94:95], v7 offset:23040
    s_waitcnt lgkmcnt(12)
    v_mfma_f32_32x32x16_bf16 v[96:111], v[72:75], v[148:151], v[96:111]
    s_waitcnt lgkmcnt(10)
    v_mfma_f32_32x32x16_bf16 v[112:127], v[76:79], v[148:151], v[112:127]
    s_waitcnt lgkmcnt(7)
    v_mfma_f32_32x32x16_bf16 v[96:111], v[80:83], v[152:155], v[96:111]
    s_waitcnt lgkmcnt(5)
    v_mfma_f32_32x32x16_bf16 v[112:127], v[84:87], v[152:155], v[112:127]
    s_waitcnt lgkmcnt(2)
    v_mfma_f32_32x32x16_bf16 v[96:111], v[88:91], v[156:159], v[96:111]
    s_waitcnt lgkmcnt(0)
    v_mfma_f32_32x32x16_bf16 v[112:127], v[92:95], v[156:159], v[112:127]
    s_waitcnt vmcnt(0)
    v_readfirstlane_b32 s10, v21
    s_mov_b32 s11, 0
    s_cmp_lg_u32 s10, 0
    s_cbranch_scc1 Lnone_2
    v_mov_b32 v22, 0
Lnon_1:
    global_load_dword v21, v22, s[36:37] sc1
    s_add_u32 s11, s11, 1
    s_waitcnt vmcnt(0)
    v_readfirstlane_b32 s10, v21
    s_cmp_gt_u32 s11, 200000
    s_cbranch_scc1 Lnone_2
    s_cmp_eq_u32 s10, 0
    s_cbranch_scc1 Lnon_1
Lnone_2:
    s_getreg_b32 s95, hwreg(HW_REG_XCC_ID, 0, 4)
    s_add_u32 s95, s95, 1
    s_xor_b32 s95, s95, s10
    v_mov_b32 v54, s95
    s_mov_b64 exec, 1
    buffer_store_dword v54, off, s[40:43], s92
    s_mov_b64 exec, -1
    s_barrier
    ds_read_b128 v[160:163], v2 offset:32768
    ds_read_b64_tr_b16 v[64:65], v6 offset:8192
    ds_read_b64_tr_b16 v[66:67], v6 offset:8704
    ds_read_b64_tr_b16 v[68:69], v7 offset:8192
    ds_read_b64_tr_b16 v[70:71], v7 offset:8704
    ds_read_b128 v[164:167], v3 offset:32768
    ds_read_b64_tr_b16 v[72:73], v6 offset:10240
    ds_read_b64_tr_b16 v[74:75], v6 offset:10752
    ds_read_b64_tr_b16 v[76:77], v7 offset:10240
    ds_read_b64_tr_b16 v[78:79], v7 offset:10752
    ds_read_b128 v[168:171], v4 offset:32768
    ds_read_b64_tr_b16 v[80:81], v6 offset:12288
    ds_read_b64_tr_b16 v[82:83], v6 offset:12800
    ds_read_b64_tr_b16 v[84:85], v7 offset:12288
    ds_read_b64_tr_b16 v[86:87], v7 offset:12800
    s_waitcnt lgkmcnt(12)
    v_mfma_f32_32x32x16_bf16 v[96:111], v[64:67], v[160:163], v[96:111]
    s_waitcnt lgkmcnt(10)
    v_mfma_f32_32x32x16_bf16 v[112:127], v[68:71], v[160:163], v[112:127]
    ds_read_b128 v[172:175], v5 offset:32768
    ds_read_b64_tr_b16 v[88:89], v6 offset:14336
    ds_read_b64_tr_b16 v[90:91], v6 offset:14848
    ds_read_b64_tr_b16 v[92:93], v7 offset:14336
    ds_read_b64_tr_b16 v[94:95], v7 offset:14848
    s_waitcnt lgkmcnt(12)
    v_mfma_f32_32x32x16_bf16 v[96:111], v[72:75], v[164:167], v[96:111]
    s_waitcnt lgkmcnt(10)
    v_mfma_f32_32x32x16_bf16 v[112:127], v[76:79], v[164:167], v[112:127]
    s_waitcnt lgkmcnt(7)
    v_mfma_f32_32x32x16_bf16 v[96:111], v[80:83], v[168:171], v[96:111]
    s_waitcnt lgkmcnt(5)
    v_mfma_f32_32x32x16_bf16 v[112:127], v[84:87], v[168:171], v[112:127]
    s_waitcnt lgkmcnt(2)
    v_mfma_f32_32x32x16_bf16 v[96:111], v[88:91], v[172:175], v[96:111]
    s_waitcnt lgkmcnt(0)
    v_mfma_f32_32x32x16_bf16 v[112:127], v[92:95], v[172:175], v[112:127]
    s_barrier
    ds_read_b128 v[176:179], v2 offset:49152
    ds_read_b64_tr_b16 v[64:65], v6 offset:0
    ds_read_b64_tr_b16 v[66:67], v6 offset:512
    ds_read_b64_tr_b16 v[68:69], v7 offset:0
    ds_read_b64_tr_b16 v[70:71], v7 offset:512
    ds_read_b128 v[180:183], v3 offset:49152
    ds_read_b64_tr_b16 v[72:73], v6 offset:2048
    ds_read_b64_tr_b16 v[74:75], v6 offset:2560
    ds_read_b64_tr_b16 v[76:77], v7 offset:2048
    ds_read_b64_tr_b16 v[78:79], v7 offset:2560
    ds_read_b128 v[184:187], v4 offset:49152
    ds_read_b64_tr_b16 v[80:81], v6 offset:4096
    ds_read_b64_tr_b16 v[82:83], v6 offset:4608
    ds_read_b64_tr_b16 v[84:85], v7 offset:4096
    ds_read_b64_tr_b16 v[86:87], v7 offset:4608
    s_waitcnt lgkmcnt(12)
    v_mfma_f32_32x32x16_bf16 v[96:111], v[64:67], v[176:179], v[96:111]
    s_waitcnt lgkmcnt(10)
    v_mfma_f32_32x32x16_bf16 v[112:127], v[68:71], v[176:179], v[112:127]
    ds_read_b128 v[188:191], v5 offset:49152
    ds_read_b64_tr_b16 v[88:89], v6 offset:6144
    ds_read_b64_tr_b16 v[90:91], v6 offset:6656
    ds_read_b64_tr_b16 v[92:93], v7 offset:6144
    ds_read_b64_tr_b16 v[94:95], v7 offset:6656
    s_waitcnt lgkmcnt(12)
    v_mfma_f32_32x32x16_bf16 v[96:111], v[72:75], v[180:183], v[96:111]
    s_waitcnt lgkmcnt(10)
    v_mfma_f32_32x32x16_bf16 v[112:127], v[76:79], v[180:183], v[112:127]
    s_waitcnt lgkmcnt(7)
    v_mfma_f32_32x32x16_bf16 v[96:111], v[80:83], v[184:187], v[96:111]
    s_waitcnt lgkmcnt(5)
    v_mfma_f32_32x32x16_bf16 v[112:127], v[84:87], v[184:187], v[112:127]
    s_waitcnt lgkmcnt(2)
    v_mfma_f32_32x32x16_bf16 v[96:111], v[88:91], v[188:191], v[96:111]
    s_waitcnt lgkmcnt(0)
    v_mfma_f32_32x32x16_bf16 v[112:127], v[92:95], v[188:191], v[112:127]
    v_lshlrev_b32 v22, 2, v0
    v_cmp_gt_u32 vcc, 32, v0
    buffer_load_dword v23, v22, s[40:43], s93 offen sc1
    s_add_u32 m0, s90, 120064
    v_cndmask_b32 v55, v21, v54, vcc
    s_barrier
    ds_read_b128 v[192:195], v2 offset:0
    ds_read_b64_tr_b16 v[64:65], v6 offset:24576
    ds_read_b64_tr_b16 v[66:67], v6 offset:25088
    ds_read_b64_tr_b16 v[68:69], v7 offset:24576
    ds_read_b64_tr_b16 v[70:71], v7 offset:25088
    ds_read_b128 v[196:199], v3 offset:0
    ds_read_b64_tr_b16 v[72:73], v6 offset:26624
    ds_read_b64_tr_b16 v[74:75], v6 offset:27136
    ds_read_b64_tr_b16 v[76:77], v7 offset:26624
    ds_read_b64_tr_b16 v[78:79], v7 offset:27136
    ds_read_b128 v[200:203], v4 offset:0
    ds_read_b64_tr_b16 v[80:81], v6 offset:28672
    ds_read_b64_tr_b16 v[82:83], v6 offset:29184
    ds_read_b64_tr_b16 v[84:85], v7 offset:28672
    ds_read_b64_tr_b16 v[86:87], v7 offset:29184
    s_waitcnt lgkmcnt(12)
    v_mfma_f32_32x32x16_bf16 v[96:111], v[64:67], v[192:195], v[96:111]
    s_waitcnt lgkmcnt(10)
    v_mfma_f32_32x32x16_bf16 v[112:127], v[68:71], v[192:195], v[112:127]
    ds_read_b128 v[204:207], v5 offset:0
    ds_read_b64_tr_b16 v[88:89], v6 offset:30720
    ds_read_b64_tr_b16 v[90:91], v6 offset:31232
    ds_read_b64_tr_b16 v[92:93], v7 offset:30720
    ds_read_b64_tr_b16 v[94:95], v7 offset:31232
    s_waitcnt lgkmcnt(12)
    v_mfma_f32_32x32x16_bf16 v[96:111], v[72:75], v[196:199], v[96:111]
    s_waitcnt lgkmcnt(10)
    v_mfma_f32_32x32x16_bf16 v[112:127], v[76:79], v[196:199], v[112:127]
    s_waitcnt lgkmcnt(7)
    v_mfma_f32_32x32x16_bf16 v[96:111], v[80:83], v[200:203], v[96:111]
    s_waitcnt lgkmcnt(5)
    v_mfma_f32_32x32x16_bf16 v[112:127], v[84:87], v[200:203], v[112:127]
    s_waitcnt lgkmcnt(2)
    v_mfma_f32_32x32x16_bf16 v[96:111], v[88:91], v[204:207], v[96:111]
    s_waitcnt lgkmcnt(0)
    v_mfma_f32_32x32x16_bf16 v[112:127], v[92:95], v[204:207], v[112:127]
    s_waitcnt vmcnt(0)
    v_cmp_ne_u32 vcc, v55, v23
    s_mov_b32 s94, 1
    s_cmp_lg_u32 vcc_lo, 0
    s_cbranch_scc1 Lum_3
Luj_4:
    s_add_u32 s14, s38, 8388608
    s_addc_u32 s15, s39, 0
    s_cmp_lg_u32 s94, 0
    s_cselect_b32 s95, s95, s10
    s_cselect_b64 s[68:69], s[34:35], s[14:15]
    s_mov_b32 s70, 0x400000
    s_mov_b32 s71, 0x20000
    v_mov_b32 v54, s95
    s_cselect_b32 s13, 0, 8192
    buffer_load_dwordx4 v52, s[68:71], s25 offen sc1 lds
    s_add_u32 m0, s90, 121088
    s_add_u32 s80, s80, s13
    buffer_load_dwordx4 v52, s[68:71], s26 offen sc1 lds
    s_add_u32 s88, s88, s13
    s_barrier
    ds_read_b128 v[208:211], v2 offset:16384
    ds_read_b64_tr_b16 v[64:65], v6 offset:16384
    ds_read_b64_tr_b16 v[66:67], v6 offset:16896
    ds_read_b64_tr_b16 v[68:69], v7 offset:16384
    ds_read_b64_tr_b16 v[70:71], v7 offset:16896
    ds_read_b128 v[212:215], v3 offset:16384
    ds_read_b64_tr_b16 v[72:73], v6 offset:18432
    ds_read_b64_tr_b16 v[74:75], v6 offset:18944
    ds_read_b64_tr_b16 v[76:77], v7 offset:18432
    ds_read_b64_tr_b16 v[78:79], v7 offset:18944
    ds_read_b128 v[216:219], v4 offset:16384
    ds_read_b64_tr_b16 v[80:81], v6 offset:20480
    ds_read_b64_tr_b16 v[82:83], v6 offset:20992
    ds_read_b64_tr_b16 v[84:85], v7 offset:20480
    ds_read_b64_tr_b16 v[86:87], v7 offset:20992
    s_waitcnt lgkmcnt(12)
    v_mfma_f32_32x32x16_bf16 v[96:111], v[64:67], v[208:211], v[96:111]
    s_waitcnt lgkmcnt(10)
    v_mfma_f32_32x32x16_bf16 v[112:127], v[68:71], v[208:211], v[112:127]
    ds_read_b128 v[220:223], v5 offset:16384
    ds_read_b64_tr_b16 v[88:89], v6 offset:22528
    ds_read_b64_tr_b16 v[90:91], v6 offset:23040
    ds_read_b64_tr_b16 v[92:93], v7 offset:22528
    ds_read_b64_tr_b16 v[94:95], v7 offset:23040
    s_waitcnt lgkmcnt(12)
    v_mfma_f32_32x32x16_bf16 v[96:111], v[72:75], v[212:215], v[96:111]
    s_waitcnt lgkmcnt(10)
    v_mfma_f32_32x32x16_bf16 v[112:127], v[76:79], v[212:215], v[112:127]
    s_waitcnt lgkmcnt(7)
    v_mfma_f32_32x32x16_bf16 v[96:111], v[80:83], v[216:219], v[96:111]
    s_waitcnt lgkmcnt(5)
    v_mfma_f32_32x32x16_bf16 v[112:127], v[84:87], v[216:219], v[112:127]
    s_waitcnt lgkmcnt(2)
    v_mfma_f32_32x32x16_bf16 v[96:111], v[88:91], v[220:223], v[96:111]
    s_waitcnt lgkmcnt(0)
    v_mfma_f32_32x32x16_bf16 v[112:127], v[92:95], v[220:223], v[112:127]
    s_barrier
    ds_read_b128 v[224:227], v2 offset:32768
    ds_read_b64_tr_b16 v[64:65], v6 offset:8192
    ds_read_b64_tr_b16 v[66:67], v6 offset:8704
    ds_read_b64_tr_b16 v[68:69], v7 offset:8192
    ds_read_b64_tr_b16 v[70:71], v7 offset:8704
    ds_read_b128 v[228:231], v3 offset:32768
    ds_read_b64_tr_b16 v[72:73], v6 offset:10240
    ds_read_b64_tr_b16 v[74:75], v6 offset:10752
    ds_read_b64_tr_b16 v[76:77], v7 offset:10240
    ds_read_b64_tr_b16 v[78:79], v7 offset:10752
    ds_read_b128 v[232:235], v4 offset:32768
    ds_read_b64_tr_b16 v[80:81], v6 offset:12288
    ds_read_b64_tr_b16 v[82:83], v6 offset:12800
    ds_read_b64_tr_b16 v[84:85], v7 offset:12288
    ds_read_b64_tr_b16 v[86:87], v7 offset:12800
    s_waitcnt lgkmcnt(12)
    v_mfma_f32_32x32x16_bf16 v[96:111], v[64:67], v[224:227], v[96:111]
    s_waitcnt lgkmcnt(10)
    v_mfma_f32_32x32x16_bf16 v[112:127], v[68:71], v[224:227], v[112:127]
    ds_read_b128 v[236:239], v5 offset:32768
    ds_read_b64_tr_b16 v[88:89], v6 offset:14336
    ds_read_b64_tr_b16 v[90:91], v6 offset:14848
    ds_read_b64_tr_b16 v[92:93], v7 offset:14336
    ds_read_b64_tr_b16 v[94:95], v7 offset:14848
    s_waitcnt lgkmcnt(12)
    v_mfma_f32_32x32x16_bf16 v[96:111], v[72:75], v[228:231], v[96:111]
    s_waitcnt lgkmcnt(10)
    v_mfma_f32_32x32x16_bf16 v[112:127], v[76:79], v[228:231], v[112:127]
    s_waitcnt lgkmcnt(7)
    v_mfma_f32_32x32x16_bf16 v[96:111], v[80:83], v[232:235], v[96:111]
    s_waitcnt lgkmcnt(5)
    v_mfma_f32_32x32x16_bf16 v[112:127], v[84:87], v[232:235], v[112:127]
    s_waitcnt lgkmcnt(2)
    v_mfma_f32_32x32x16_bf16 v[96:111], v[88:91], v[236:239], v[96:111]
    s_waitcnt lgkmcnt(0)
    v_mfma_f32_32x32x16_bf16 v[112:127], v[92:95], v[236:239], v[112:127]
    s_waitcnt vmcnt(0)
    s_barrier
    ds_read_b128 v[240:243], v2 offset:49152
    ds_read_b64_tr_b16 v[64:65], v6 offset:0
    ds_read_b64_tr_b16 v[66:67], v6 offset:512
    ds_read_b64_tr_b16 v[68:69], v7 offset:0
    ds_read_b64_tr_b16 v[70:71], v7 offset:512
    ds_read_b128 v[244:247], v3 offset:49152
    ds_read_b64_tr_b16 v[72:73], v6 offset:2048
    ds_read_b64_tr_b16 v[74:75], v6 offset:2560
    ds_read_b64_tr_b16 v[76:77], v7 offset:2048
    ds_read_b64_tr_b16 v[78:79], v7 offset:2560
    ds_read_b128 v[248:251], v4 offset:49152
    ds_read_b64_tr_b16 v[80:81], v6 offset:4096
    ds_read_b64_tr_b16 v[82:83], v6 offset:4608
    ds_read_b64_tr_b16 v[84:85], v7 offset:4096
    ds_read_b64_tr_b16 v[86:87], v7 offset:4608
    s_waitcnt lgkmcnt(12)
    v_mfma_f32_32x32x16_bf16 v[96:111], v[64:67], v[240:243], v[96:111]
    s_waitcnt lgkmcnt(10)
    v_mfma_f32_32x32x16_bf16 v[112:127], v[68:71], v[240:243], v[112:127]
    ds_read_b128 v[252:255], v5 offset:49152
    ds_read_b64_tr_b16 v[88:89], v6 offset:6144
    ds_read_b64_tr_b16 v[90:91], v6 offset:6656
    ds_read_b64_tr_b16 v[92:93], v7 offset:6144
    ds_read_b64_tr_b16 v[94:95], v7 offset:6656
    s_waitcnt lgkmcnt(12)
    v_mfma_f32_32x32x16_bf16 v[96:111], v[72:75], v[244:247], v[96:111]
    s_waitcnt lgkmcnt(10)
    v_mfma_f32_32x32x16_bf16 v[112:127], v[76:79], v[244:247], v[112:127]
    s_waitcnt lgkmcnt(7)
    v_mfma_f32_32x32x16_bf16 v[96:111], v[80:83], v[248:251], v[96:111]
    s_waitcnt lgkmcnt(5)
    v_mfma_f32_32x32x16_bf16 v[112:127], v[84:87], v[248:251], v[112:127]
    s_waitcnt lgkmcnt(2)
    v_mfma_f32_32x32x16_bf16 v[96:111], v[88:91], v[252:255], v[96:111]
    s_waitcnt lgkmcnt(0)
    v_mfma_f32_32x32x16_bf16 v[112:127], v[92:95], v[252:255], v[112:127]
    s_nop 9
    v_cvt_pk_bf16_f32 v64, v96, v97
    v_cvt_pk_bf16_f32 v65, v98, v99
    v_cvt_pk_bf16_f32 v66, v100, v101
    v_cvt_pk_bf16_f32 v67, v102, v103
    s_add_u32 s12, s83, 0
    buffer_store_dwordx4 v[64:67], v9, s[40:43], s12 offen sc1
    v_cvt_pk_bf16_f32 v72, v112, v113
    v_cvt_pk_bf16_f32 v73, v114, v115
    v_cvt_pk_bf16_f32 v74, v116, v117
    v_cvt_pk_bf16_f32 v75, v118, v119
    s_add_u32 s12, s83, 262144
    buffer_store_dwordx4 v[72:75], v9, s[40:43], s12 offen sc1
    v_cvt_pk_bf16_f32 v68, v104, v105
    v_cvt_pk_bf16_f32 v69, v106, v107
    v_cvt_pk_bf16_f32 v70, v108, v109
    v_cvt_pk_bf16_f32 v71, v110, v111
    s_add_u32 s12, s83, 131072
    buffer_store_dwordx4 v[68:71], v9, s[40:43], s12 offen sc1
    v_cvt_pk_bf16_f32 v76, v120, v121
    v_cvt_pk_bf16_f32 v77, v122, v123
    v_cvt_pk_bf16_f32 v78, v124, v125
    v_cvt_pk_bf16_f32 v79, v126, v127
    s_add_u32 s12, s83, 393216
    buffer_store_dwordx4 v[76:79], v9, s[40:43], s12 offen sc1
    s_branch L_qpart
L_vgemm:
    s_barrier
    ds_read_b128 v[128:131], v2 offset:0
    ds_read_b64_tr_b16 v[64:65], v6 offset:24576
    ds_read_b64_tr_b16 v[66:67], v6 offset:25088
    ds_read_b64_tr_b16 v[68:69], v7 offset:24576
    ds_read_b64_tr_b16 v[70:71], v7 offset:25088
    ds_read_b128 v[132:135], v3 offset:0
    ds_read_b64_tr_b16 v[72:73], v6 offset:26624
    ds_read_b64_tr_b16 v[74:75], v6 offset:27136
    ds_read_b64_tr_b16 v[76:77], v7 offset:26624
    ds_read_b64_tr_b16 v[78:79], v7 offset:27136
    ds_read_b128 v[136:139], v4 offset:0
    ds_read_b64_tr_b16 v[80:81], v6 offset:28672
    ds_read_b64_tr_b16 v[82:83], v6 offset:29184
    ds_read_b64_tr_b16 v[84:85], v7 offset:28672
    ds_read_b64_tr_b16 v[86:87], v7 offset:29184
    s_waitcnt lgkmcnt(12)
    v_mfma_f32_32x32x16_bf16 v[96:111], v[128:131], v[64:67], 0
    s_waitcnt lgkmcnt(10)
    v_mfma_f32_32x32x16_bf16 v[112:127], v[128:131], v[68:71], 0
    ds_read_b128 v[140:143], v5 offset:0
    ds_read_b64_tr_b16 v[88:89], v6 offset:30720
    ds_read_b64_tr_b16 v[90:91], v6 offset:31232
    ds_read_b64_tr_b16 v[92:93], v7 offset:30720
    ds_read_b64_tr_b16 v[94:95], v7 offset:31232
    s_waitcnt lgkmcnt(12)
    v_mfma_f32_32x32x16_bf16 v[96:111], v[132:135], v[72:75], v[96:111]
    s_waitcnt lgkmcnt(10)
    v_mfma_f32_32x32x16_bf16 v[112:127], v[132:135], v[76:79], v[112:127]
    s_waitcnt lgkmcnt(7)
    v_mfma_f32_32x32x16_bf16 v[96:111], v[136:139], v[80:83], v[96:111]
    s_waitcnt lgkmcnt(5)
    v_mfma_f32_32x32x16_bf16 v[112:127], v[136:139], v[84:87], v[112:127]
    s_waitcnt lgkmcnt(2)
    v_mfma_f32_32x32x16_bf16 v[96:111], v[140:143], v[88:91], v[96:111]
    s_waitcnt lgkmcnt(0)
    v_mfma_f32_32x32x16_bf16 v[112:127], v[140:143], v[92:95], v[112:127]
    s_barrier
    ds_read_b128 v[144:147], v2 offset:16384
    ds_read_b64_tr_b16 v[64:65], v6 offset:16384
    ds_read_b64_tr_b16 v[66:67], v6 offset:16896
    ds_read_b64_tr_b16 v[68:69], v7 offset:16384
    ds_read_b64_tr_b16 v[70:71], v7 offset:16896
    ds_read_b128 v[148:151], v3 offset:16384
    ds_read_b64_tr_b16 v[72:73], v6 offset:18432
    ds_read_b64_tr_b16 v[74:75], v6 offset:18944
    ds_read_b64_tr_b16 v[76:77], v7 offset:18432
    ds_read_b64_tr_b16 v[78:79], v7 offset:18944
    ds_read_b128 v[152:155], v4 offset:16384
    ds_read_b64_tr_b16 v[80:81], v6 offset:20480
    ds_read_b64_tr_b16 v[82:83], v6 offset:20992
    ds_read_b64_tr_b16 v[84:85], v7 offset:20480
    ds_read_b64_tr_b16 v[86:87], v7 offset:20992
    s_waitcnt lgkmcnt(12)
    v_mfma_f32_32x32x16_bf16 v[96:111], v[144:147], v[64:67], v[96:111]
    s_waitcnt lgkmcnt(10)
    v_mfma_f32_32x32x16_bf16 v[112:127], v[144:147], v[68:71], v[112:127]
    ds_read_b128 v[156:159], v5 offset:16384
    ds_read_b64_tr_b16 v[88:89], v6 offset:22528
    ds_read_b64_tr_b16 v[90:91], v6 offset:23040
    ds_read_b64_tr_b16 v[92:93], v7 offset:22528
    ds_read_b64_tr_b16 v[94:95], v7 offset:23040
    s_waitcnt lgkmcnt(12)
    v_mfma_f32_32x32x16_bf16 v[96:111], v[148:151], v[72:75], v[96:111]
    s_waitcnt lgkmcnt(10)
    v_mfma_f32_32x32x16_bf16 v[112:127], v[148:151], v[76:79], v[112:127]
    s_waitcnt lgkmcnt(7)
    v_mfma_f32_32x32x16_bf16 v[96:111], v[152:155], v[80:83], v[96:111]
    s_waitcnt lgkmcnt(5)
    v_mfma_f32_32x32x16_bf16 v[112:127], v[152:155], v[84:87], v[112:127]
    s_waitcnt lgkmcnt(2)
    v_mfma_f32_32x32x16_bf16 v[96:111], v[156:159], v[88:91], v[96:111]
    s_waitcnt lgkmcnt(0)
    v_mfma_f32_32x32x16_bf16 v[112:127], v[156:159], v[92:95], v[112:127]
    s_waitcnt vmcnt(0)
    v_readfirstlane_b32 s10, v21
    s_mov_b32 s11, 0
    s_cmp_lg_u32 s10, 0
    s_cbranch_scc1 Lnone_8
    v_mov_b32 v22, 0
Lnon_7:
    global_load_dword v21, v22, s[36:37] sc1
    s_add_u32 s11, s11, 1
    s_waitcnt vmcnt(0)
    v_readfirstlane_b32 s10, v21
    s_cmp_gt_u32 s11, 200000
    s_cbranch_scc1 Lnone_8
    s_cmp_eq_u32 s10, 0
    s_cbranch_scc1 Lnon_7
Lnone_8:
    s_getreg_b32 s95, hwreg(HW_REG_XCC_ID, 0, 4)
    s_add_u32 s95, s95, 1
    s_xor_b32 s95, s95, s10
    v_mov_b32 v54, s95
    s_mov_b64 exec, 1
    buffer_store_dword v54, off, s[40:43], s92
    s_mov_b64 exec, -1
    s_barrier
    ds_read_b128 v[160:163], v2 offset:32768
    ds_read_b64_tr_b16 v[64:65], v6 offset:8192
    ds_read_b64_tr_b16 v[66:67], v6 offset:8704
    ds_read_b64_tr_b16 v[68:69], v7 offset:8192
    ds_read_b64_tr_b16 v[70:71], v7 offset:8704
    ds_read_b128 v[164:167], v3 offset:32768
    ds_read_b64_tr_b16 v[72:73], v6 offset:10240
    ds_read_b64_tr_b16 v[74:75], v6 offset:10752
    ds_read_b64_tr_b16 v[76:77], v7 offset:10240
    ds_read_b64_tr_b16 v[78:79], v7 offset:10752
    ds_read_b128 v[168:171], v4 offset:32768
    ds_read_b64_tr_b16 v[80:81], v6 offset:12288
    ds_read_b64_tr_b16 v[82:83], v6 offset:12800
    ds_read_b64_tr_b16 v[84:85], v7 offset:12288
    ds_read_b64_tr_b16 v[86:87], v7 offset:12800
    s_waitcnt lgkmcnt(12)
    v_mfma_f32_32x32x16_bf16 v[96:111], v[160:163], v[64:67], v[96:111]
    s_waitcnt lgkmcnt(10)
    v_mfma_f32_32x32x16_bf16 v[112:127], v[160:163], v[68:71], v[112:127]
    ds_read_b128 v[172:175], v5 offset:32768
    ds_read_b64_tr_b16 v[88:89], v6 offset:14336
    ds_read_b64_tr_b16 v[90:91], v6 offset:14848
    ds_read_b64_tr_b16 v[92:93], v7 offset:14336
    ds_read_b64_tr_b16 v[94:95], v7 offset:14848
    s_waitcnt lgkmcnt(12)
    v_mfma_f32_32x32x16_bf16 v[96:111], v[164:167], v[72:75], v[96:111]
    s_waitcnt lgkmcnt(10)
    v_mfma_f32_32x32x16_bf16 v[112:127], v[164:167], v[76:79], v[112:127]
    s_waitcnt lgkmcnt(7)
    v_mfma_f32_32x32x16_bf16 v[96:111], v[168:171], v[80:83], v[96:111]
    s_waitcnt lgkmcnt(5)
    v_mfma_f32_32x32x16_bf16 v[112:127], v[168:171], v[84:87], v[112:127]
    s_waitcnt lgkmcnt(2)
    v_mfma_f32_32x32x16_bf16 v[96:111], v[172:175], v[88:91], v[96:111]
    s_waitcnt lgkmcnt(0)
    v_mfma_f32_32x32x16_bf16 v[112:127], v[172:175], v[92:95], v[112:127]
    s_barrier
    ds_read_b128 v[176:179], v2 offset:49152
    ds_read_b64_tr_b16 v[64:65], v6 offset:0
    ds_read_b64_tr_b16 v[66:67], v6 offset:512
    ds_read_b64_tr_b16 v[68:69], v7 offset:0
    ds_read_b64_tr_b16 v[70:71], v7 offset:512
    ds_read_b128 v[180:183], v3 offset:49152
    ds_read_b64_tr_b16 v[72:73], v6 offset:2048
    ds_read_b64_tr_b16 v[74:75], v6 offset:2560
    ds_read_b64_tr_b16 v[76:77], v7 offset:2048
    ds_read_b64_tr_b16 v[78:79], v7 offset:2560
    ds_read_b128 v[184:187], v4 offset:49152
    ds_read_b64_tr_b16 v[80:81], v6 offset:4096
    ds_read_b64_tr_b16 v[82:83], v6 offset:4608
    ds_read_b64_tr_b16 v[84:85], v7 offset:4096
    ds_read_b64_tr_b16 v[86:87], v7 offset:4608
    s_waitcnt lgkmcnt(12)
    v_mfma_f32_32x32x16_bf16 v[96:111], v[176:179], v[64:67], v[96:111]
    s_waitcnt lgkmcnt(10)
    v_mfma_f32_32x32x16_bf16 v[112:127], v[176:179], v[68:71], v[112:127]
    ds_read_b128 v[188:191], v5 offset:49152
    ds_read_b64_tr_b16 v[88:89], v6 offset:6144
    ds_read_b64_tr_b16 v[90:91], v6 offset:6656
    ds_read_b64_tr_b16 v[92:93], v7 offset:6144
    ds_read_b64_tr_b16 v[94:95], v7 offset:6656
    s_waitcnt lgkmcnt(12)
    v_mfma_f32_32x32x16_bf16 v[96:111], v[180:183], v[72:75], v[96:111]
    s_waitcnt lgkmcnt(10)
    v_mfma_f32_32x32x16_bf16 v[112:127], v[180:183], v[76:79], v[112:127]
    s_waitcnt lgkmcnt(7)
    v_mfma_f32_32x32x16_bf16 v[96:111], v[184:187], v[80:83], v[96:111]
    s_waitcnt lgkmcnt(5)
    v_mfma_f32_32x32x16_bf16 v[112:127], v[184:187], v[84:87], v[112:127]
    s_waitcnt lgkmcnt(2)
    v_mfma_f32_32x32x16_bf16 v[96:111], v[188:191], v[88:91], v[96:111]
    s_waitcnt lgkmcnt(0)
    v_mfma_f32_32x32x16_bf16 v[112:127], v[188:191], v[92:95], v[112:127]
    v_lshlrev_b32 v22, 2, v0
    v_cmp_gt_u32 vcc, 32, v0
    buffer_load_dword v23, v22, s[40:43], s93 offen sc1
    s_add_u32 m0, s90, 120064
    v_cndmask_b32 v55, v21, v54, vcc
    s_barrier
    ds_read_b128 v[192:195], v2 offset:0
    ds_read_b64_tr_b16 v[64:65], v6 offset:24576
    ds_read_b64_tr_b16 v[66:67], v6 offset:25088
    ds_read_b64_tr_b16 v[68:69], v7 offset:24576
    ds_read_b64_tr_b16 v[70:71], v7 offset:25088
    ds_read_b128 v[196:199], v3 offset:0
    ds_read_b64_tr_b16 v[72:73], v6 offset:26624
    ds_read_b64_tr_b16 v[74:75], v6 offset:27136
    ds_read_b64_tr_b16 v[76:77], v7 offset:26624
    ds_read_b64_tr_b16 v[78:79], v7 offset:27136
    ds_read_b128 v[200:203], v4 offset:0
    ds_read_b64_tr_b16 v[80:81], v6 offset:28672
    ds_read_b64_tr_b16 v[82:83], v6 offset:29184
    ds_read_b64_tr_b16 v[84:85], v7 offset:28672
    ds_read_b64_tr_b16 v[86:87], v7 offset:29184
    s_waitcnt lgkmcnt(12)
    v_mfma_f32_32x32x16_bf16 v[96:111], v[192:195], v[64:67], v[96:111]
    s_waitcnt lgkmcnt(10)
    v_mfma_f32_32x32x16_bf16 v[112:127], v[192:195], v[68:71], v[112:127]
    ds_read_b128 v[204:207], v5 offset:0
    ds_read_b64_tr_b16 v[88:89], v6 offset:30720
    ds_read_b64_tr_b16 v[90:91], v6 offset:31232
    ds_read_b64_tr_b16 v[92:93], v7 offset:30720
    ds_read_b64_tr_b16 v[94:95], v7 offset:31232
    s_waitcnt lgkmcnt(12)
    v_mfma_f32_32x32x16_bf16 v[96:111], v[196:199], v[72:75], v[96:111]
    s_waitcnt lgkmcnt(10)
    v_mfma_f32_32x32x16_bf16 v[112:127], v[196:199], v[76:79], v[112:127]
    s_waitcnt lgkmcnt(7)
    v_mfma_f32_32x32x16_bf16 v[96:111], v[200:203], v[80:83], v[96:111]
    s_waitcnt lgkmcnt(5)
    v_mfma_f32_32x32x16_bf16 v[112:127], v[200:203], v[84:87], v[112:127]
    s_waitcnt lgkmcnt(2)
    v_mfma_f32_32x32x16_bf16 v[96:111], v[204:207], v[88:91], v[96:111]
    s_waitcnt lgkmcnt(0)
    v_mfma_f32_32x32x16_bf16 v[112:127], v[204:207], v[92:95], v[112:127]
    s_waitcnt vmcnt(0)
    v_cmp_ne_u32 vcc, v55, v23
    s_mov_b32 s94, 1
    s_cmp_lg_u32 vcc_lo, 0
    s_cbranch_scc1 Lum_9
Luj_10:
    s_add_u32 s14, s38, 8388608
    s_addc_u32 s15, s39, 0
    s_cmp_lg_u32 s94, 0
    s_cselect_b32 s95, s95, s10
    s_cselect_b64 s[68:69], s[34:35], s[14:15]
    s_mov_b32 s70, 0x400000
    s_mov_b32 s71, 0x20000
    v_mov_b32 v54, s95
    s_cselect_b32 s13, 0, 8192
    buffer_load_dwordx4 v52, s[68:71], s25 offen sc1 lds
    s_add_u32 m0, s90, 121088
    s_add_u32 s80, s80, s13
    buffer_load_dwordx4 v52, s[68:71], s26 offen sc1 lds
    s_add_u32 s88, s88, s13
    s_barrier
    ds_read_b128 v[208:211], v2 offset:16384
    ds_read_b64_tr_b16 v[64:65], v6 offset:16384
    ds_read_b64_tr_b16 v[66:67], v6 offset:16896
    ds_read_b64_tr_b16 v[68:69], v7 offset:16384
    ds_read_b64_tr_b16 v[70:71], v7 offset:16896
    ds_read_b128 v[212:215], v3 offset:16384
    ds_read_b64_tr_b16 v[72:73], v6 offset:18432
    ds_read_b64_tr_b16 v[74:75], v6 offset:18944
    ds_read_b64_tr_b16 v[76:77], v7 offset:18432
    ds_read_b64_tr_b16 v[78:79], v7 offset:18944
    ds_read_b128 v[216:219], v4 offset:16384
    ds_read_b64_tr_b16 v[80:81], v6 offset:20480
    ds_read_b64_tr_b16 v[82:83], v6 offset:20992
    ds_read_b64_tr_b16 v[84:85], v7 offset:20480
    ds_read_b64_tr_b16 v[86:87], v7 offset:20992
    s_waitcnt lgkmcnt(12)
    v_mfma_f32_32x32x16_bf16 v[96:111], v[208:211], v[64:67], v[96:111]
    s_waitcnt lgkmcnt(10)
    v_mfma_f32_32x32x16_bf16 v[112:127], v[208:211], v[68:71], v[112:127]
    ds_read_b128 v[220:223], v5 offset:16384
    ds_read_b64_tr_b16 v[88:89], v6 offset:22528
    ds_read_b64_tr_b16 v[90:91], v6 offset:23040
    ds_read_b64_tr_b16 v[92:93], v7 offset:22528
    ds_read_b64_tr_b16 v[94:95], v7 offset:23040
    s_waitcnt lgkmcnt(12)
    v_mfma_f32_32x32x16_bf16 v[96:111], v[212:215], v[72:75], v[96:111]
    s_waitcnt lgkmcnt(10)
    v_mfma_f32_32x32x16_bf16 v[112:127], v[212:215], v[76:79], v[112:127]
    s_waitcnt lgkmcnt(7)
    v_mfma_f32_32x32x16_bf16 v[96:111], v[216:219], v[80:83], v[96:111]
    s_waitcnt lgkmcnt(5)
    v_mfma_f32_32x32x16_bf16 v[112:127], v[216:219], v[84:87], v[112:127]
    s_waitcnt lgkmcnt(2)
    v_mfma_f32_32x32x16_bf16 v[96:111], v[220:223], v[88:91], v[96:111]
    s_waitcnt lgkmcnt(0)
    v_mfma_f32_32x32x16_bf16 v[112:127], v[220:223], v[92:95], v[112:127]
    s_barrier
    ds_read_b128 v[224:227], v2 offset:32768
    ds_read_b64_tr_b16 v[64:65], v6 offset:8192
    ds_read_b64_tr_b16 v[66:67], v6 offset:8704
    ds_read_b64_tr_b16 v[68:69], v7 offset:8192
    ds_read_b64_tr_b16 v[70:71], v7 offset:8704
    ds_read_b128 v[228:231], v3 offset:32768
    ds_read_b64_tr_b16 v[72:73], v6 offset:10240
    ds_read_b64_tr_b16 v[74:75], v6 offset:10752
    ds_read_b64_tr_b16 v[76:77], v7 offset:10240
    ds_read_b64_tr_b16 v[78:79], v7 offset:10752
    ds_read_b128 v[232:235], v4 offset:32768
    ds_read_b64_tr_b16 v[80:81], v6 offset:12288
    ds_read_b64_tr_b16 v[82:83], v6 offset:12800
    ds_read_b64_tr_b16 v[84:85], v7 offset:12288
    ds_read_b64_tr_b16 v[86:87], v7 offset:12800
    s_waitcnt lgkmcnt(12)
    v_mfma_f32_32x32x16_bf16 v[96:111], v[224:227], v[64:67], v[96:111]
    s_waitcnt lgkmcnt(10)
    v_mfma_f32_32x32x16_bf16 v[112:127], v[224:227], v[68:71], v[112:127]
    ds_read_b128 v[236:239], v5 offset:32768
    ds_read_b64_tr_b16 v[88:89], v6 offset:14336
    ds_read_b64_tr_b16 v[90:91], v6 offset:14848
    ds_read_b64_tr_b16 v[92:93], v7 offset:14336
    ds_read_b64_tr_b16 v[94:95], v7 offset:14848
    s_waitcnt lgkmcnt(12)
    v_mfma_f32_32x32x16_bf16 v[96:111], v[228:231], v[72:75], v[96:111]
    s_waitcnt lgkmcnt(10)
    v_mfma_f32_32x32x16_bf16 v[112:127], v[228:231], v[76:79], v[112:127]
    s_waitcnt lgkmcnt(7)
    v_mfma_f32_32x32x16_bf16 v[96:111], v[232:235], v[80:83], v[96:111]
    s_waitcnt lgkmcnt(5)
    v_mfma_f32_32x32x16_bf16 v[112:127], v[232:235], v[84:87], v[112:127]
    s_waitcnt lgkmcnt(2)
    v_mfma_f32_32x32x16_bf16 v[96:111], v[236:239], v[88:91], v[96:111]
    s_waitcnt lgkmcnt(0)
    v_mfma_f32_32x32x16_bf16 v[112:127], v[236:239], v[92:95], v[112:127]
    s_waitcnt vmcnt(0)
    s_barrier
    ds_read_b128 v[240:243], v2 offset:49152
    ds_read_b64_tr_b16 v[64:65], v6 offset:0
    ds_read_b64_tr_b16 v[66:67], v6 offset:512
    ds_read_b64_tr_b16 v[68:69], v7 offset:0
    ds_read_b64_tr_b16 v[70:71], v7 offset:512
    ds_read_b128 v[244:247], v3 offset:49152
    ds_read_b64_tr_b16 v[72:73], v6 offset:2048
    ds_read_b64_tr_b16 v[74:75], v6 offset:2560
    ds_read_b64_tr_b16 v[76:77], v7 offset:2048
    ds_read_b64_tr_b16 v[78:79], v7 offset:2560
    ds_read_b128 v[248:251], v4 offset:49152
    ds_read_b64_tr_b16 v[80:81], v6 offset:4096
    ds_read_b64_tr_b16 v[82:83], v6 offset:4608
    ds_read_b64_tr_b16 v[84:85], v7 offset:4096
    ds_read_b64_tr_b16 v[86:87], v7 offset:4608
    s_waitcnt lgkmcnt(12)
    v_mfma_f32_32x32x16_bf16 v[96:111], v[240:243], v[64:67], v[96:111]
    s_waitcnt lgkmcnt(10)
    v_mfma_f32_32x32x16_bf16 v[112:127], v[240:243], v[68:71], v[112:127]
    ds_read_b128 v[252:255], v5 offset:49152
    ds_read_b64_tr_b16 v[88:89], v6 offset:6144
    ds_read_b64_tr_b16 v[90:91], v6 offset:6656
    ds_read_b64_tr_b16 v[92:93], v7 offset:6144
    ds_read_b64_tr_b16 v[94:95], v7 offset:6656
    s_waitcnt lgkmcnt(12)
    v_mfma_f32_32x32x16_bf16 v[96:111], v[244:247], v[72:75], v[96:111]
    s_waitcnt lgkmcnt(10)
    v_mfma_f32_32x32x16_bf16 v[112:127], v[244:247], v[76:79], v[112:127]
    s_waitcnt lgkmcnt(7)
    v_mfma_f32_32x32x16_bf16 v[96:111], v[248:251], v[80:83], v[96:111]
    s_waitcnt lgkmcnt(5)
    v_mfma_f32_32x32x16_bf16 v[112:127], v[248:251], v[84:87], v[112:127]
    s_waitcnt lgkmcnt(2)
    v_mfma_f32_32x32x16_bf16 v[96:111], v[252:255], v[88:91], v[96:111]
    s_waitcnt lgkmcnt(0)
    v_mfma_f32_32x32x16_bf16 v[112:127], v[252:255], v[92:95], v[112:127]
    s_nop 9
    v_cvt_pk_bf16_f32 v64, v96, v97
    v_cvt_pk_bf16_f32 v65, v98, v99
    v_cvt_pk_bf16_f32 v66, v100, v101
    v_cvt_pk_bf16_f32 v67, v102, v103
    v_cvt_pk_bf16_f32 v68, v104, v105
    v_cvt_pk_bf16_f32 v69, v106, v107
    v_cvt_pk_bf16_f32 v70, v108, v109
    v_cvt_pk_bf16_f32 v71, v110, v111
    s_nop 0
    v_permlane16_swap_b32 v64, v68
    v_permlane16_swap_b32 v65, v69
    v_permlane16_swap_b32 v66, v70
    v_permlane16_swap_b32 v67, v71
    s_add_u32 s12, s83, 0
    buffer_store_dwordx4 v[64:67], v11, s[40:43], s12 offen sc1
    v_cvt_pk_bf16_f32 v72, v112, v113
    v_cvt_pk_bf16_f32 v73, v114, v115
    v_cvt_pk_bf16_f32 v74, v116, v117
    v_cvt_pk_bf16_f32 v75, v118, v119
    v_cvt_pk_bf16_f32 v76, v120, v121
    v_cvt_pk_bf16_f32 v77, v122, v123
    v_cvt_pk_bf16_f32 v78, v124, v125
    v_cvt_pk_bf16_f32 v79, v126, v127
    s_nop 0
    v_permlane16_swap_b32 v72, v76
    v_permlane16_swap_b32 v73, v77
    v_permlane16_swap_b32 v74, v78
    v_permlane16_swap_b32 v75, v79
    s_add_u32 s12, s83, 262144
    buffer_store_dwordx4 v[72:75], v11, s[40:43], s12 offen sc1
    s_add_u32 s12, s83, 131072
    buffer_store_dwordx4 v[68:71], v11, s[40:43], s12 offen sc1
    s_add_u32 s12, s83, 393216
    buffer_store_dwordx4 v[76:79], v11, s[40:43], s12 offen sc1
L_qpart:
    s_lshl_b32 s12, s9, 3
    s_add_u32 s12, s12, 93696
    v_mov_b32 v26, s12
    v_mov_b32 v27, s94
    s_mov_b64 exec, 1
    ds_write2_b32 v26, v21, v27 offset0:0 offset1:1
    s_mov_b64 exec, -1
    v_mov_b32 v1, 1
    ds_write_b32 v24, v1
    v_mov_b32 v22, v56
    s_mov_b32 s11, 0
Lsy_13:
    ds_read_b32 v1, v30
    s_add_u32 s11, s11, 1
    s_cmp_gt_u32 s11, 800000
    s_waitcnt lgkmcnt(0)
    v_cmp_gt_u32 vcc, 1, v1
    s_cbranch_scc1 Lsye_14
    s_cbranch_vccnz Lsy_13
Lsye_14:
    s_setprio 2
    ds_read_b64_tr_b16 v[80:81], v10 offset:0
    ds_read_b64_tr_b16 v[82:83], v10 offset:256
    ds_read_b64_tr_b16 v[84:85], v10 offset:1024
    ds_read_b64_tr_b16 v[86:87], v10 offset:1280
    ds_read_b64_tr_b16 v[88:89], v10 offset:2048
    ds_read_b64_tr_b16 v[90:91], v10 offset:2304
    s_waitcnt lgkmcnt(4)
    v_mfma_f32_32x32x16_bf16 v[96:111], v[80:83], v[128:131], 0
    ds_read_b64_tr_b16 v[92:93], v10 offset:3072
    ds_read_b64_tr_b16 v[94:95], v10 offset:3328
    s_waitcnt lgkmcnt(4)
    v_mfma_f32_32x32x16_bf16 v[96:111], v[84:87], v[132:135], v[96:111]
    ds_read_b64_tr_b16 v[80:81], v8 offset:4096
    ds_read_b64_tr_b16 v[82:83], v8 offset:4352
    s_waitcnt lgkmcnt(4)
    v_mfma_f32_32x32x16_bf16 v[96:111], v[88:91], v[136:139], v[96:111]
    ds_read_b64_tr_b16 v[84:85], v8 offset:5120
    ds_read_b64_tr_b16 v[86:87], v8 offset:5376
    s_waitcnt lgkmcnt(4)
    v_mfma_f32_32x32x16_bf16 v[96:111], v[92:95], v[140:143], v[96:111]
    ds_read_b64_tr_b16 v[88:89], v8 offset:6144
    ds_read_b64_tr_b16 v[90:91], v8 offset:6400
    s_waitcnt lgkmcnt(4)
    v_mfma_f32_32x32x16_bf16 v[96:111], v[80:83], v[144:147], v[96:111]
    ds_read_b64_tr_b16 v[92:93], v8 offset:7168
    ds_read_b64_tr_b16 v[94:95], v8 offset:7424
    s_waitcnt lgkmcnt(4)
    v_mfma_f32_32x32x16_bf16 v[96:111], v[84:87], v[148:151], v[96:111]
    ds_read_b64_tr_b16 v[80:81], v10 offset:32768
    ds_read_b64_tr_b16 v[82:83], v10 offset:33024
    s_waitcnt lgkmcnt(4)
    v_mfma_f32_32x32x16_bf16 v[96:111], v[88:91], v[152:155], v[96:111]
    ds_read_b64_tr_b16 v[84:85], v10 offset:33792
    ds_read_b64_tr_b16 v[86:87], v10 offset:34048
    s_waitcnt lgkmcnt(4)
    v_mfma_f32_32x32x16_bf16 v[96:111], v[92:95], v[156:159], v[96:111]
    ds_read_b64_tr_b16 v[88:89], v10 offset:34816
    ds_read_b64_tr_b16 v[90:91], v10 offset:35072
    s_waitcnt lgkmcnt(4)
    v_mfma_f32_32x32x16_bf16 v[96:111], v[80:83], v[160:163], v[96:111]
    ds_read_b64_tr_b16 v[92:93], v10 offset:35840
    ds_read_b64_tr_b16 v[94:95], v10 offset:36096
    s_waitcnt lgkmcnt(4)
    v_mfma_f32_32x32x16_bf16 v[96:111], v[84:87], v[164:167], v[96:111]
    ds_read_b64_tr_b16 v[80:81], v8 offset:12288
    ds_read_b64_tr_b16 v[82:83], v8 offset:12544
    s_waitcnt lgkmcnt(4)
    v_mfma_f32_32x32x16_bf16 v[96:111], v[88:91], v[168:171], v[96:111]
    ds_read_b64_tr_b16 v[84:85], v8 offset:13312
    ds_read_b64_tr_b16 v[86:87], v8 offset:13568
    s_waitcnt lgkmcnt(4)
    v_mfma_f32_32x32x16_bf16 v[96:111], v[92:95], v[172:175], v[96:111]
    ds_read_b64_tr_b16 v[88:89], v8 offset:14336
    ds_read_b64_tr_b16 v[90:91], v8 offset:14592
    s_waitcnt lgkmcnt(4)
    v_mfma_f32_32x32x16_bf16 v[96:111], v[80:83], v[176:179], v[96:111]
    ds_read_b64_tr_b16 v[92:93], v8 offset:15360
    ds_read_b64_tr_b16 v[94:95], v8 offset:15616
    s_waitcnt vmcnt(0)
    s_mov_b64 exec, 1
    buffer_store_dword v21, off, s[40:43], s84 sc1
    s_mov_b64 exec, -1
    s_waitcnt lgkmcnt(4)
    v_mfma_f32_32x32x16_bf16 v[96:111], v[84:87], v[180:183], v[96:111]
    ds_read_b64_tr_b16 v[80:81], v8 offset:16384
    ds_read_b64_tr_b16 v[82:83], v8 offset:16640
    s_waitcnt lgkmcnt(4)
    v_mfma_f32_32x32x16_bf16 v[96:111], v[88:91], v[184:187], v[96:111]
    ds_read_b64_tr_b16 v[84:85], v8 offset:17408
    ds_read_b64_tr_b16 v[86:87], v8 offset:17664
    s_waitcnt lgkmcnt(4)
    v_mfma_f32_32x32x16_bf16 v[96:111], v[92:95], v[188:191], v[96:111]
    ds_read_b64_tr_b16 v[88:89], v8 offset:18432
    ds_read_b64_tr_b16 v[90:91], v8 offset:18688
    s_waitcnt lgkmcnt(4)
    v_mfma_f32_32x32x16_bf16 v[96:111], v[80:83], v[192:195], v[96:111]
    ds_read_b64_tr_b16 v[92:93], v8 offset:19456
    ds_read_b64_tr_b16 v[94:95], v8 offset:19712
    s_waitcnt lgkmcnt(4)
    v_mfma_f32_32x32x16_bf16 v[96:111], v[84:87], v[196:199], v[96:111]
    ds_read_b64_tr_b16 v[80:81], v8 offset:20480
    ds_read_b64_tr_b16 v[82:83], v8 offset:20736
    s_waitcnt lgkmcnt(4)
    v_mfma_f32_32x32x16_bf16 v[96:111], v[88:91], v[200:203], v[96:111]
    ds_read_b64_tr_b16 v[84:85], v8 offset:21504
    ds_read_b64_tr_b16 v[86:87], v8 offset:21760
    s_waitcnt lgkmcnt(4)
    v_mfma_f32_32x32x16_bf16 v[96:111], v[92:95], v[204:207], v[96:111]
    ds_read_b64_tr_b16 v[88:89], v8 offset:22528
    ds_read_b64_tr_b16 v[90:91], v8 offset:22784
    s_waitcnt lgkmcnt(4)
    v_mfma_f32_32x32x16_bf16 v[96:111], v[80:83], v[208:211], v[96:111]
    ds_read_b64_tr_b16 v[92:93], v8 offset:23552
    ds_read_b64_tr_b16 v[94:95], v8 offset:23808
    s_waitcnt lgkmcnt(4)
    v_mfma_f32_32x32x16_bf16 v[96:111], v[84:87], v[212:215], v[96:111]
    ds_read_b64_tr_b16 v[80:81], v8 offset:24576
    ds_read_b64_tr_b16 v[82:83], v8 offset:24832
    s_waitcnt lgkmcnt(4)
    v_mfma_f32_32x32x16_bf16 v[96:111], v[88:91], v[216:219], v[96:111]
    ds_read_b64_tr_b16 v[84:85], v8 offset:25600
    ds_read_b64_tr_b16 v[86:87], v8 offset:25856
    s_waitcnt lgkmcnt(4)
    v_mfma_f32_32x32x16_bf16 v[96:111], v[92:95], v[220:223], v[96:111]
    ds_read_b64_tr_b16 v[88:89], v8 offset:26624
    ds_read_b64_tr_b16 v[90:91], v8 offset:26880
    s_waitcnt lgkmcnt(4)
    v_mfma_f32_32x32x16_bf16 v[96:111], v[80:83], v[224:227], v[96:111]
    ds_read_b64_tr_b16 v[92:93], v8 offset:27648
    ds_read_b64_tr_b16 v[94:95], v8 offset:27904
    s_waitcnt lgkmcnt(4)
    v_mfma_f32_32x32x16_bf16 v[96:111], v[84:87], v[228:231], v[96:111]
    ds_read_b64_tr_b16 v[80:81], v8 offset:28672
    ds_read_b64_tr_b16 v[82:83], v8 offset:28928
    s_waitcnt lgkmcnt(4)
    v_mfma_f32_32x32x16_bf16 v[96:111], v[88:91], v[232:235], v[96:111]
    ds_read_b64_tr_b16 v[84:85], v8 offset:29696
    ds_read_b64_tr_b16 v[86:87], v8 offset:29952
    s_waitcnt lgkmcnt(4)
    v_mfma_f32_32x32x16_bf16 v[96:111], v[92:95], v[236:239], v[96:111]
    ds_read_b64_tr_b16 v[88:89], v8 offset:30720
    ds_read_b64_tr_b16 v[90:91], v8 offset:30976
    s_waitcnt lgkmcnt(4)
    v_mfma_f32_32x32x16_bf16 v[96:111], v[80:83], v[240:243], v[96:111]
    ds_read_b64_tr_b16 v[92:93], v8 offset:31744
    ds_read_b64_tr_b16 v[94:95], v8 offset:32000
    s_waitcnt lgkmcnt(4)
    v_mfma_f32_32x32x16_bf16 v[96:111], v[84:87], v[244:247], v[96:111]
    s_waitcnt lgkmcnt(2)
    v_mfma_f32_32x32x16_bf16 v[96:111], v[88:91], v[248:251], v[96:111]
    s_waitcnt lgkmcnt(0)
    v_mfma_f32_32x32x16_bf16 v[96:111], v[92:95], v[252:255], v[96:111]
    v_mov_b32 v1, 2
    ds_write_b32 v24, v1
    s_mov_b32 s11, 0
Lsy_15:
    ds_read_b32 v1, v25
    s_add_u32 s11, s11, 1
    s_cmp_gt_u32 s11, 800000
    s_waitcnt lgkmcnt(0)
    v_cmp_gt_u32 vcc, 1, v1
    s_cbranch_scc1 Lsye_16
    s_cbranch_vccnz Lsy_15
Lsye_16:
    s_mov_b64 exec, 0xffffff
    ds_write2_b32 v58, v59, v59 offset0:0 offset1:1
    ds_write2_b32 v58, v59, v59 offset0:2 offset1:3
    s_mov_b64 exec, -1
    s_lshl_b32 s12, s9, 10
    s_add_u32 s12, s12, 94208
    v_add_u32 v29, s12, v9
    v_mul_f32 v96, s89, v96
    v_mul_f32 v97, s89, v97
    v_mul_f32 v98, s89, v98
    v_mul_f32 v99, s89, v99
    v_mul_f32 v100, s89, v100
    v_mul_f32 v101, s89, v101
    v_mul_f32 v102, s89, v102
    v_mul_f32 v103, s89, v103
    v_mul_f32 v104, s89, v104
    v_mul_f32 v105, s89, v105
    v_mul_f32 v106, s89, v106
    v_mul_f32 v107, s89, v107
    v_mul_f32 v108, s89, v108
    v_mul_f32 v109, s89, v109
    v_mul_f32 v110, s89, v110
    v_mul_f32 v111, s89, v111
    buffer_load_dword v23, v22, s[40:43], s85 offen sc1
    v_cvt_pk_bf16_f32 v80, v104, v105
    v_cvt_pk_bf16_f32 v81, v106, v107
    v_cvt_pk_bf16_f32 v82, v108, v109
    v_cvt_pk_bf16_f32 v83, v110, v111
    ds_write_b128 v29, v[80:83]
    v_cvt_pk_bf16_f32 v12, v96, v97
    v_cvt_pk_bf16_f32 v13, v98, v99
    v_cvt_pk_bf16_f32 v14, v100, v101
    v_cvt_pk_bf16_f32 v15, v102, v103
    ds_read_b128 v[160:163], v19 offset:1408
    ds_read_b128 v[164:167], v19 offset:1280
    ds_read_b128 v[168:171], v19 offset:1152
    ds_read_b128 v[172:175], v19 offset:1024
    ds_read_b128 v[176:179], v19 offset:384
    ds_read_b128 v[180:183], v19 offset:256
    ds_read_b128 v[184:187], v19 offset:128
    ds_read_b128 v[188:191], v19 offset:0
    s_waitcnt vmcnt(0)
    v_cmp_ne_u32 vcc, s10, v23
    s_mov_b32 s11, 0
    s_cbranch_vccz Lpolle_18
Lpoll_17:
    buffer_load_dword v23, v22, s[40:43], s85 offen sc1
    s_add_u32 s11, s11, 1
    s_waitcnt vmcnt(0)
    v_cmp_ne_u32 vcc, s10, v23
    s_cmp_gt_u32 s11, 200000
    s_cbranch_scc1 Lpolle_18
    s_cbranch_vccnz Lpoll_17
Lpolle_18:
    s_add_u32 m0, s16, 0
    s_add_u32 s12, s17, 0
    buffer_load_dwordx4 v9, s[40:43], s12 offen sc1 lds
    buffer_load_dwordx4 v9, s[40:43], s12 offen offset:1024 sc1 lds
    s_add_u32 m0, s18, 0
    s_add_u32 s12, s19, 0
    buffer_load_dwordx4 v9, s[40:43], s12 offen sc1 lds
    buffer_load_dwordx4 v9, s[40:43], s12 offen offset:1024 sc1 lds
    s_add_u32 m0, s20, 0
    s_add_u32 s12, s21, 0
    buffer_load_dwordx4 v9, s[40:43], s12 offen sc1 lds
    buffer_load_dwordx4 v9, s[40:43], s12 offen offset:1024 sc1 lds
    v_bfe_u32 v26, v0, 2, 3
    v_and_b32 v27, 32, v0
    v_add_u32 v27, v27, v26
    v_lshrrev_b32 v26, 1, v26
    v_lshlrev_b32 v26, 5, v26
    v_lshl_add_u32 v26, v27, 7, v26
    v_and_b32 v27, 3, v0
    v_lshl_add_u32 v26, v27, 3, v26
    v_add_u32 v2, 98304, v26
    v_xor_b32 v3, 32, v2
    v_xor_b32 v4, 64, v2
    v_xor_b32 v5, 0x60, v2
    s_and_b32 s86, s5, 7
    s_lshl_b32 s86, s86, 7
    s_sub_u32 s83, s87, 4194304
    s_lshl_b32 s83, s83, 2
    s_add_u32 s83, s83, s86
    s_add_u32 s83, s83, 1024
    s_add_u32 s91, s83, 16384
    v_and_b32 v22, 15, v0
    v_lshlrev_b32 v22, 2, v22
    s_mul_i32 s12, s9, 2304
    s_add_u32 s12, s12, 0
    v_and_b32 v26, 15, v0
    v_mul_u32_u24 v26, 144, v26
    v_lshrrev_b32 v27, 4, v0
    v_lshl_add_u32 v26, v27, 3, v26
    v_add_u32 v6, s12, v26
    v_lshrrev_b32 v27, 3, v0
    v_lshl_add_u32 v27, v27, 4, v9
    v_add_u32 v7, s12, v27
    s_add_u32 m0, s16, 24768
    s_add_u32 s12, s17, 131072
    buffer_load_dwordx4 v9, s[40:43], s12 offen sc1 lds
    buffer_load_dwordx4 v9, s[40:43], s12 offen offset:1024 sc1 lds
    s_add_u32 m0, s18, 24768
    s_add_u32 s12, s19, 131072
    buffer_load_dwordx4 v9, s[40:43], s12 offen sc1 lds
    buffer_load_dwordx4 v9, s[40:43], s12 offen offset:1024 sc1 lds
    s_add_u32 m0, s20, 24768
    s_add_u32 s12, s21, 131072
    buffer_load_dwordx4 v9, s[40:43], s12 offen sc1 lds
    buffer_load_dwordx4 v9, s[40:43], s12 offen offset:1024 sc1 lds
    s_waitcnt vmcnt(8)
    v_mov_b32 v1, 3
    ds_write_b32 v24, v1
    s_mov_b32 s11, 0
Lsy_19:
    ds_read_b32 v1, v25
    s_add_u32 s11, s11, 1
    s_cmp_gt_u32 s11, 800000
    s_waitcnt lgkmcnt(0)
    v_cmp_gt_u32 vcc, 3, v1
    s_cbranch_scc1 Lsye_20
    s_cbranch_vccnz Lsy_19
Lsye_20:
    ds_read_b128 v[200:203], v16 offset:8256
    ds_read_b128 v[204:207], v16 offset:6192
    ds_read_b128 v[208:211], v17 offset:8256
    ds_read_b128 v[212:215], v18 offset:8256
    v_mov_b32 v29, 4
    s_waitcnt lgkmcnt(3)
    v_mfma_f32_32x32x16_bf16 v[128:143], v[200:203], v[12:15], 0
    s_nop 11
    v_exp_f32 v128, v128
    v_exp_f32 v129, v129
    v_exp_f32 v130, v130
    v_exp_f32 v131, v131
    v_cvt_pk_bf16_f32 v192, v128, v129
    v_exp_f32 v132, v132
    v_exp_f32 v133, v133
    v_cvt_pk_bf16_f32 v193, v130, v131
    s_waitcnt lgkmcnt(0)
    v_mfma_f32_32x32x16_bf16 v[144:159], v[204:207], v[12:15], 0
    ds_read_b128 v[200:203], v16 offset:10320
    v_exp_f32 v134, v134
    v_exp_f32 v135, v135
    v_cvt_pk_bf16_f32 v194, v132, v133
    v_exp_f32 v136, v136
    v_exp_f32 v137, v137
    v_cvt_pk_bf16_f32 v195, v134, v135
    v_exp_f32 v138, v138
    v_exp_f32 v139, v139
    v_mfma_f32_32x32x16_bf16 v[96:111], v[208:211], v[192:195], 0
    ds_read_b128 v[216:219], v17 offset:6192
    ds_read_b128 v[220:223], v18 offset:6192
    v_cvt_pk_bf16_f32 v196, v136, v137
    v_exp_f32 v140, v140
    v_exp_f32 v141, v141
    v_cvt_pk_bf16_f32 v197, v138, v139
    v_exp_f32 v142, v142
    v_exp_f32 v143, v143
    v_cvt_pk_bf16_f32 v198, v140, v141
    v_cvt_pk_bf16_f32 v199, v142, v143
    v_exp_f32 v144, v144
    v_exp_f32 v145, v145
    v_mfma_f32_32x32x16_bf16 v[96:111], v[212:215], v[196:199], v[96:111]
    v_exp_f32 v146, v146
    v_exp_f32 v147, v147
    v_cvt_pk_bf16_f32 v192, v144, v145
    v_exp_f32 v148, v148
    v_exp_f32 v149, v149
    v_cvt_pk_bf16_f32 v193, v146, v147
    s_waitcnt lgkmcnt(0)
    v_mfma_f32_32x32x16_bf16 v[128:143], v[200:203], v[12:15], 0
    ds_read_b128 v[204:207], v16 offset:4128
    v_exp_f32 v150, v150
    v_exp_f32 v151, v151
    v_cvt_pk_bf16_f32 v194, v148, v149
    v_exp_f32 v152, v152
    v_exp_f32 v153, v153
    v_cvt_pk_bf16_f32 v195, v150, v151
    v_exp_f32 v154, v154
    v_exp_f32 v155, v155
    v_mfma_f32_32x32x16_bf16 v[96:111], v[216:219], v[192:195], v[96:111]
    ds_read_b128 v[208:211], v17 offset:10320
    ds_read_b128 v[212:215], v18 offset:10320
    v_cvt_pk_bf16_f32 v196, v152, v153
    v_exp_f32 v156, v156
    v_exp_f32 v157, v157
    v_cvt_pk_bf16_f32 v197, v154, v155
    v_exp_f32 v158, v158
    v_exp_f32 v159, v159
    v_cvt_pk_bf16_f32 v198, v156, v157
    v_cvt_pk_bf16_f32 v199, v158, v159
    v_exp_f32 v128, v128
    v_exp_f32 v129, v129
    v_mfma_f32_32x32x16_bf16 v[96:111], v[220:223], v[196:199], v[96:111]
    s_waitcnt vmcnt(6)
    ds_write_b32 v24, v29
    v_exp_f32 v130, v130
    v_exp_f32 v131, v131
    v_cvt_pk_bf16_f32 v192, v128, v129
    v_exp_f32 v132, v132
    v_exp_f32 v133, v133
    v_cvt_pk_bf16_f32 v193, v130, v131
    s_waitcnt lgkmcnt(0)
    v_mfma_f32_32x32x16_bf16 v[144:159], v[204:207], v[12:15], 0
    ds_read_b128 v[200:203], v16 offset:12384
    v_exp_f32 v134, v134
    v_exp_f32 v135, v135
    v_cvt_pk_bf16_f32 v194, v132, v133
    v_exp_f32 v136, v136
    v_exp_f32 v137, v137
    v_cvt_pk_bf16_f32 v195, v134, v135
    v_exp_f32 v138, v138
    v_exp_f32 v139, v139
    v_mfma_f32_32x32x16_bf16 v[96:111], v[208:211], v[192:195], v[96:111]
    ds_read_b128 v[216:219], v17 offset:4128
    ds_read_b128 v[220:223], v18 offset:4128
    v_cvt_pk_bf16_f32 v196, v136, v137
    v_exp_f32 v140, v140
    v_exp_f32 v141, v141
    v_cvt_pk_bf16_f32 v197, v138, v139
    v_exp_f32 v142, v142
    v_exp_f32 v143, v143
    v_cvt_pk_bf16_f32 v198, v140, v141
    v_cvt_pk_bf16_f32 v199, v142, v143
    v_exp_f32 v144, v144
    v_exp_f32 v145, v145
    v_mfma_f32_32x32x16_bf16 v[96:111], v[212:215], v[196:199], v[96:111]
    ds_read_b32 v1, v25
    v_exp_f32 v146, v146
    v_exp_f32 v147, v147
    v_cvt_pk_bf16_f32 v192, v144, v145
    v_exp_f32 v148, v148
    v_exp_f32 v149, v149
    v_cvt_pk_bf16_f32 v193, v146, v147
    s_waitcnt lgkmcnt(0)
    v_cmp_gt_u32 vcc, 4, v1
    v_mfma_f32_32x32x16_bf16 v[128:143], v[200:203], v[12:15], 0
    s_cbranch_vccz Lsb_21
    s_mov_b32 s11, 0
Lsy_22:
    ds_read_b32 v1, v25
    s_add_u32 s11, s11, 1
    s_cmp_gt_u32 s11, 800000
    s_waitcnt lgkmcnt(0)
    v_cmp_gt_u32 vcc, 4, v1
    s_cbranch_scc1 Lsye_23
    s_cbranch_vccnz Lsy_22
Lsye_23:
Lsb_21:
    ds_read_b128 v[204:207], v16 offset:2064
    v_exp_f32 v150, v150
    v_exp_f32 v151, v151
    v_cvt_pk_bf16_f32 v194, v148, v149
    v_exp_f32 v152, v152
    v_exp_f32 v153, v153
    v_cvt_pk_bf16_f32 v195, v150, v151
    v_exp_f32 v154, v154
    v_exp_f32 v155, v155
    v_mfma_f32_32x32x16_bf16 v[96:111], v[216:219], v[192:195], v[96:111]
    ds_read_b128 v[208:211], v17 offset:12384
    ds_read_b128 v[212:215], v18 offset:12384
    v_cvt_pk_bf16_f32 v196, v152, v153
    v_exp_f32 v156, v156
    v_exp_f32 v157, v157
    v_cvt_pk_bf16_f32 v197, v154, v155
    v_exp_f32 v158, v158
    v_exp_f32 v159, v159
    v_cvt_pk_bf16_f32 v198, v156, v157
    v_cvt_pk_bf16_f32 v199, v158, v159
    v_exp_f32 v128, v128
    v_exp_f32 v129, v129
    v_mfma_f32_32x32x16_bf16 v[96:111], v[220:223], v[196:199], v[96:111]
    v_exp_f32 v130, v130
    v_exp_f32 v131, v131
    v_cvt_pk_bf16_f32 v192, v128, v129
    v_exp_f32 v132, v132
    v_exp_f32 v133, v133
    v_cvt_pk_bf16_f32 v193, v130, v131
    s_waitcnt lgkmcnt(0)
    v_mfma_f32_32x32x16_bf16 v[144:159], v[204:207], v[12:15], 0
    ds_read_b128 v[200:203], v16 offset:14448
    v_exp_f32 v134, v134
    v_exp_f32 v135, v135
    v_cvt_pk_bf16_f32 v194, v132, v133
    v_exp_f32 v136, v136
    v_exp_f32 v137, v137
    v_cvt_pk_bf16_f32 v195, v134, v135
    v_exp_f32 v138, v138
    v_exp_f32 v139, v139
    v_mfma_f32_32x32x16_bf16 v[96:111], v[208:211], v[192:195], v[96:111]
    ds_read_b128 v[216:219], v17 offset:2064
    ds_read_b128 v[220:223], v18 offset:2064
    v_cvt_pk_bf16_f32 v196, v136, v137
    v_exp_f32 v140, v140
    v_exp_f32 v141, v141
    v_cvt_pk_bf16_f32 v197, v138, v139
    v_exp_f32 v142, v142
    v_exp_f32 v143, v143
    v_cvt_pk_bf16_f32 v198, v140, v141
    v_cvt_pk_bf16_f32 v199, v142, v143
    s_waitcnt vmcnt(0)
    v_mov_b32 v1, 5
    ds_write_b32 v24, v1
    v_exp_f32 v144, v144
    v_exp_f32 v145, v145
    v_mfma_f32_32x32x16_bf16 v[96:111], v[212:215], v[196:199], v[96:111]
    v_exp_f32 v146, v146
    v_exp_f32 v147, v147
    v_cvt_pk_bf16_f32 v192, v144, v145
    v_exp_f32 v148, v148
    v_exp_f32 v149, v149
    v_cvt_pk_bf16_f32 v193, v146, v147
    s_waitcnt lgkmcnt(0)
    v_mfma_f32_32x32x16_bf16 v[128:143], v[200:203], v[12:15], 0
    ds_read_b128 v[204:207], v16 offset:0
    v_exp_f32 v150, v150
    v_exp_f32 v151, v151
    v_cvt_pk_bf16_f32 v194, v148, v149
    v_exp_f32 v152, v152
    v_exp_f32 v153, v153
    v_cvt_pk_bf16_f32 v195, v150, v151
    v_exp_f32 v154, v154
    v_exp_f32 v155, v155
    v_mfma_f32_32x32x16_bf16 v[96:111], v[216:219], v[192:195], v[96:111]
    ds_read_b128 v[208:211], v17 offset:14448
    ds_read_b128 v[212:215], v18 offset:14448
    v_cvt_pk_bf16_f32 v196, v152, v153
    v_exp_f32 v156, v156
    v_exp_f32 v157, v157
    v_cvt_pk_bf16_f32 v197, v154, v155
    v_exp_f32 v158, v158
    v_exp_f32 v159, v159
    v_cvt_pk_bf16_f32 v198, v156, v157
    v_cvt_pk_bf16_f32 v199, v158, v159
    v_exp_f32 v128, v128
    v_exp_f32 v129, v129
    v_mfma_f32_32x32x16_bf16 v[96:111], v[220:223], v[196:199], v[96:111]
    v_exp_f32 v130, v130
    v_exp_f32 v131, v131
    v_cvt_pk_bf16_f32 v192, v128, v129
    v_exp_f32 v132, v132
    v_exp_f32 v133, v133
    v_cvt_pk_bf16_f32 v193, v130, v131
    s_waitcnt lgkmcnt(0)
    v_mfma_f32_32x32x16_bf16 v[144:159], v[204:207], v[12:15], v[160:175]
    ds_read_b128 v[200:203], v16 offset:16512
    v_exp_f32 v134, v134
    v_exp_f32 v135, v135
    v_cvt_pk_bf16_f32 v194, v132, v133
    v_exp_f32 v136, v136
    v_exp_f32 v137, v137
    v_cvt_pk_bf16_f32 v195, v134, v135
    v_exp_f32 v138, v138
    v_exp_f32 v139, v139
    v_mfma_f32_32x32x16_bf16 v[96:111], v[208:211], v[192:195], v[96:111]
    ds_read_b128 v[216:219], v17 offset:0
    ds_read_b128 v[220:223], v18 offset:0
    v_cvt_pk_bf16_f32 v196, v136, v137
    v_exp_f32 v140, v140
    v_exp_f32 v141, v141
    v_cvt_pk_bf16_f32 v197, v138, v139
    v_exp_f32 v142, v142
    v_exp_f32 v143, v143
    v_cvt_pk_bf16_f32 v198, v140, v141
    v_cvt_pk_bf16_f32 v199, v142, v143
    v_exp_f32 v144, v144
    v_exp_f32 v145, v145
    v_mfma_f32_32x32x16_bf16 v[96:111], v[212:215], v[196:199], v[96:111]
    v_exp_f32 v146, v146
    v_exp_f32 v147, v147
    v_cvt_pk_bf16_f32 v192, v144, v145
    v_exp_f32 v148, v148
    v_exp_f32 v149, v149
    v_cvt_pk_bf16_f32 v193, v146, v147
    s_waitcnt lgkmcnt(0)
    v_mfma_f32_32x32x16_bf16 v[128:143], v[200:203], v[12:15], v[176:191]
    v_exp_f32 v150, v150
    v_exp_f32 v151, v151
    v_cvt_pk_bf16_f32 v194, v148, v149
    v_exp_f32 v152, v152
    v_exp_f32 v153, v153
    v_cvt_pk_bf16_f32 v195, v150, v151
    v_exp_f32 v154, v154
    v_exp_f32 v155, v155
    v_mfma_f32_32x32x16_bf16 v[96:111], v[216:219], v[192:195], v[96:111]
    ds_read_b128 v[208:211], v17 offset:16512
    ds_read_b128 v[212:215], v18 offset:16512
    v_cvt_pk_bf16_f32 v196, v152, v153
    v_exp_f32 v156, v156
    v_exp_f32 v157, v157
    v_cvt_pk_bf16_f32 v197, v154, v155
    v_exp_f32 v158, v158
    v_exp_f32 v159, v159
    v_cvt_pk_bf16_f32 v198, v156, v157
    v_cvt_pk_bf16_f32 v199, v158, v159
    v_exp_f32 v128, v128
    v_exp_f32 v129, v129
    v_mfma_f32_32x32x16_bf16 v[96:111], v[220:223], v[196:199], v[96:111]
    v_exp_f32 v130, v130
    v_exp_f32 v131, v131
    v_cvt_pk_bf16_f32 v192, v128, v129
    v_exp_f32 v132, v132
    v_exp_f32 v133, v133
    v_cvt_pk_bf16_f32 v193, v130, v131
    s_waitcnt lgkmcnt(0)
    v_exp_f32 v134, v134
    v_exp_f32 v135, v135
    v_cvt_pk_bf16_f32 v194, v132, v133
    v_exp_f32 v136, v136
    v_exp_f32 v137, v137
    v_cvt_pk_bf16_f32 v195, v134, v135
    v_exp_f32 v138, v138
    v_exp_f32 v139, v139
    v_mfma_f32_32x32x16_bf16 v[96:111], v[208:211], v[192:195], v[96:111]
    v_cvt_pk_bf16_f32 v196, v136, v137
    v_exp_f32 v140, v140
    v_exp_f32 v141, v141
    v_cvt_pk_bf16_f32 v197, v138, v139
    v_exp_f32 v142, v142
    v_exp_f32 v143, v143
    v_cvt_pk_bf16_f32 v198, v140, v141
    v_cvt_pk_bf16_f32 v199, v142, v143
    s_nop 1
    v_mfma_f32_32x32x16_bf16 v[96:111], v[212:215], v[196:199], v[96:111]
    s_nop 11
    v_cmp_nge_f32 vcc, v104, s77
    v_cmp_nle_f32 s[14:15], v104, s78
    s_or_b64 vcc, vcc, s[14:15]
    s_cbranch_vccnz L_slow0
L_back0:
    v_rcp_f32 v104, v104
    s_nop 0
    v_pk_mul_f32 v[96:97], v[96:97], v[104:105] op_sel_hi:[1,0]
    v_pk_mul_f32 v[98:99], v[98:99], v[104:105] op_sel_hi:[1,0]
    v_pk_mul_f32 v[100:101], v[100:101], v[104:105] op_sel_hi:[1,0]
    v_pk_mul_f32 v[102:103], v[102:103], v[104:105] op_sel_hi:[1,0]
    v_cvt_pk_bf16_f32 v232, v96, v97
    v_cvt_pk_bf16_f32 v233, v98, v99
    v_cvt_pk_bf16_f32 v234, v100, v101
    v_cvt_pk_bf16_f32 v235, v102, v103
    s_cmp_eq_u32 s94, 0
    s_cbranch_scc1 Lfar_24
    buffer_store_dwordx4 v[232:235], v20, s[40:43], s79 offen
Lfarj_25:
    s_cmp_eq_u32 s94, 0
    s_mov_b64 exec, 1
    s_waitcnt vmcnt(0)
    s_cbranch_scc1 Lfar_26
    buffer_store_dword v54, off, s[40:43], s80
Lfarj_27:
    s_mov_b64 exec, -1
    s_setprio 2
    s_mov_b32 s11, 0
Lsy_28:
    ds_read_b32 v1, v30
    s_add_u32 s11, s11, 1
    s_cmp_gt_u32 s11, 800000
    s_waitcnt lgkmcnt(0)
    v_cmp_gt_u32 vcc, 4, v1
    s_cbranch_scc1 Lsye_29
    s_cbranch_vccnz Lsy_28
Lsye_29:
    s_add_u32 s11, s22, 4
    s_and_b32 s11, s11, 7
    s_lshl_b32 s12, s11, 11
    s_add_u32 m0, s12, s23
    s_lshl_b32 s11, s11, 14
    s_add_u32 s11, s11, s24
    buffer_load_dwordx4 v48, s[56:59], s11 offen lds
    buffer_load_dwordx4 v49, s[56:59], s11 offen offset:1024 lds
    s_add_u32 s11, s22, 5
    s_and_b32 s11, s11, 7
    s_lshl_b32 s12, s11, 11
    s_add_u32 m0, s12, s23
    s_lshl_b32 s11, s11, 14
    s_add_u32 s11, s11, s24
    buffer_load_dwordx4 v48, s[56:59], s11 offen lds
    buffer_load_dwordx4 v49, s[56:59], s11 offen offset:1024 lds
    s_add_u32 s11, s22, 6
    s_and_b32 s11, s11, 7
    s_lshl_b32 s12, s11, 11
    s_add_u32 m0, s12, s23
    s_lshl_b32 s11, s11, 14
    s_add_u32 s11, s11, s24
    buffer_load_dwordx4 v48, s[56:59], s11 offen lds
    buffer_load_dwordx4 v49, s[56:59], s11 offen offset:1024 lds
    s_add_u32 s11, s22, 7
    s_and_b32 s11, s11, 7
    s_lshl_b32 s12, s11, 11
    s_add_u32 m0, s12, s23
    s_lshl_b32 s11, s11, 14
    s_add_u32 s11, s11, s24
    buffer_load_dwordx4 v48, s[56:59], s11 offen lds
    buffer_load_dwordx4 v49, s[56:59], s11 offen offset:1024 lds
    s_mov_b32 s11, 0
Lpoll_30:
    buffer_load_dword v23, v22, s[40:43], s88 offen sc1
    s_add_u32 s11, s11, 1
    s_waitcnt vmcnt(0)
    v_cmp_ne_u32 vcc, s95, v23
    s_cmp_gt_u32 s11, 200000
    s_cbranch_scc1 Lpolle_31
    s_cbranch_vccnz Lpoll_30
Lpolle_31:
    s_add_u32 s12, s87, 0
    s_add_u32 s13, s12, 4096
    buffer_load_dwordx4 v[64:67], v9, s[40:43], s12 offen offset:0 sc1
    buffer_load_dwordx4 v[68:71], v9, s[40:43], s12 offen offset:1024 sc1
    buffer_load_dwordx4 v[72:75], v9, s[40:43], s12 offen offset:2048 sc1
    buffer_load_dwordx4 v[76:79], v9, s[40:43], s12 offen offset:3072 sc1
    buffer_load_dwordx4 v[80:83], v9, s[40:43], s13 offen offset:0 sc1
    buffer_load_dwordx4 v[84:87], v9, s[40:43], s13 offen offset:1024 sc1
    buffer_load_dwordx4 v[88:91], v9, s[40:43], s13 offen offset:2048 sc1
    buffer_load_dwordx4 v[92:95], v9, s[40:43], s13 offen offset:3072 sc1
    s_add_u32 s88, s88, 4096
    v_mov_b32 v1, 6
    ds_write_b32 v24, v1
    s_mov_b32 s11, 0
Lsy_32:
    ds_read_b32 v1, v30
    s_add_u32 s11, s11, 1
    s_cmp_gt_u32 s11, 800000
    s_waitcnt lgkmcnt(0)
    v_cmp_gt_u32 vcc, 5, v1
    s_cbranch_scc1 Lsye_33
    s_cbranch_vccnz Lsy_32
Lsye_33:
    s_mov_b32 s11, 0
Lsy_34:
    ds_read_b32 v1, v25
    s_add_u32 s11, s11, 1
    s_cmp_gt_u32 s11, 800000
    s_waitcnt lgkmcnt(0)
    v_cmp_gt_u32 vcc, 6, v1
    s_cbranch_scc1 Lsye_35
    s_cbranch_vccnz Lsy_34
Lsye_35:
    ds_read_b64_tr_b16 v[128:129], v2 offset:0
    ds_read_b64_tr_b16 v[130:131], v2 offset:1024
    ds_read_b64_tr_b16 v[132:133], v3 offset:0
    ds_read_b64_tr_b16 v[134:135], v3 offset:1024
    ds_read_b64_tr_b16 v[136:137], v4 offset:0
    ds_read_b64_tr_b16 v[138:139], v4 offset:1024
    ds_read_b64_tr_b16 v[140:141], v5 offset:0
    ds_read_b64_tr_b16 v[142:143], v5 offset:1024
    s_waitcnt lgkmcnt(7)
    ds_read_b64_tr_b16 v[144:145], v2 offset:8192
    ds_read_b64_tr_b16 v[146:147], v2 offset:9216
    ds_read_b64_tr_b16 v[148:149], v3 offset:8192
    ds_read_b64_tr_b16 v[150:151], v3 offset:9216
    ds_read_b64_tr_b16 v[152:153], v4 offset:8192
    ds_read_b64_tr_b16 v[154:155], v4 offset:9216
    ds_read_b64_tr_b16 v[156:157], v5 offset:8192
    ds_read_b64_tr_b16 v[158:159], v5 offset:9216
    s_waitcnt lgkmcnt(7)
    ds_read_b64_tr_b16 v[160:161], v2 offset:16384
    ds_read_b64_tr_b16 v[162:163], v2 offset:17408
    ds_read_b64_tr_b16 v[164:165], v3 offset:16384
    ds_read_b64_tr_b16 v[166:167], v3 offset:17408
    ds_read_b64_tr_b16 v[168:169], v4 offset:16384
    ds_read_b64_tr_b16 v[170:171], v4 offset:17408
    ds_read_b64_tr_b16 v[172:173], v5 offset:16384
    ds_read_b64_tr_b16 v[174:175], v5 offset:17408
    s_waitcnt lgkmcnt(7)
    ds_read_b64_tr_b16 v[176:177], v2 offset:24576
    ds_read_b64_tr_b16 v[178:179], v2 offset:25600
    ds_read_b64_tr_b16 v[180:181], v3 offset:24576
    ds_read_b64_tr_b16 v[182:183], v3 offset:25600
    ds_read_b64_tr_b16 v[184:185], v4 offset:24576
    ds_read_b64_tr_b16 v[186:187], v4 offset:25600
    ds_read_b64_tr_b16 v[188:189], v5 offset:24576
    ds_read_b64_tr_b16 v[190:191], v5 offset:25600
    s_waitcnt lgkmcnt(7)
    ds_read_b64_tr_b16 v[192:193], v2 offset:32768
    ds_read_b64_tr_b16 v[194:195], v2 offset:33792
    ds_read_b64_tr_b16 v[196:197], v3 offset:32768
    ds_read_b64_tr_b16 v[198:199], v3 offset:33792
    ds_read_b64_tr_b16 v[200:201], v4 offset:32768
    ds_read_b64_tr_b16 v[202:203], v4 offset:33792
    ds_read_b64_tr_b16 v[204:205], v5 offset:32768
    ds_read_b64_tr_b16 v[206:207], v5 offset:33792
    s_waitcnt lgkmcnt(7)
    ds_read_b64_tr_b16 v[208:209], v2 offset:40960
    ds_read_b64_tr_b16 v[210:211], v2 offset:41984
    ds_read_b64_tr_b16 v[212:213], v3 offset:40960
    ds_read_b64_tr_b16 v[214:215], v3 offset:41984
    ds_read_b64_tr_b16 v[216:217], v4 offset:40960
    ds_read_b64_tr_b16 v[218:219], v4 offset:41984
    ds_read_b64_tr_b16 v[220:221], v5 offset:40960
    ds_read_b64_tr_b16 v[222:223], v5 offset:41984
    s_waitcnt lgkmcnt(7)
    ds_read_b64_tr_b16 v[224:225], v2 offset:49152
    ds_read_b64_tr_b16 v[226:227], v2 offset:50176
    ds_read_b64_tr_b16 v[228:229], v3 offset:49152
    ds_read_b64_tr_b16 v[230:231], v3 offset:50176
    ds_read_b64_tr_b16 v[232:233], v4 offset:49152
    ds_read_b64_tr_b16 v[234:235], v4 offset:50176
    ds_read_b64_tr_b16 v[236:237], v5 offset:49152
    ds_read_b64_tr_b16 v[238:239], v5 offset:50176
    s_waitcnt lgkmcnt(7)
    ds_read_b64_tr_b16 v[240:241], v2 offset:57344
    ds_read_b64_tr_b16 v[242:243], v2 offset:58368
    ds_read_b64_tr_b16 v[244:245], v3 offset:57344
    ds_read_b64_tr_b16 v[246:247], v3 offset:58368
    ds_read_b64_tr_b16 v[248:249], v4 offset:57344
    ds_read_b64_tr_b16 v[250:251], v4 offset:58368
    ds_read_b64_tr_b16 v[252:253], v5 offset:57344
    ds_read_b64_tr_b16 v[254:255], v5 offset:58368
    s_waitcnt lgkmcnt(0)
    s_setprio 0
    s_waitcnt vmcnt(7) lgkmcnt(6)
    v_mfma_f32_16x16x32_bf16 v[96:99], v[128:131], v[64:67], 0
    v_mfma_f32_16x16x32_bf16 v[100:103], v[132:135], v[64:67], 0
    ds_read_b64_tr_b16 v[128:129], v2 offset:2048
    ds_read_b64_tr_b16 v[130:131], v2 offset:3072
    v_mfma_f32_16x16x32_bf16 v[104:107], v[136:139], v[64:67], 0
    ds_read_b64_tr_b16 v[132:133], v3 offset:2048
    ds_read_b64_tr_b16 v[134:135], v3 offset:3072
    v_mfma_f32_16x16x32_bf16 v[108:111], v[140:143], v[64:67], 0
    ds_read_b64_tr_b16 v[136:137], v4 offset:2048
    ds_read_b64_tr_b16 v[138:139], v4 offset:3072
    s_waitcnt vmcnt(6) lgkmcnt(6)
    v_mfma_f32_16x16x32_bf16 v[96:99], v[144:147], v[68:71], v[96:99]
    ds_read_b64_tr_b16 v[140:141], v5 offset:2048
    ds_read_b64_tr_b16 v[142:143], v5 offset:3072
    v_mfma_f32_16x16x32_bf16 v[100:103], v[148:151], v[68:71], v[100:103]
    ds_read_b64_tr_b16 v[144:145], v2 offset:10240
    ds_read_b64_tr_b16 v[146:147], v2 offset:11264
    v_mfma_f32_16x16x32_bf16 v[104:107], v[152:155], v[68:71], v[104:107]
    ds_read_b64_tr_b16 v[148:149], v3 offset:10240
    ds_read_b64_tr_b16 v[150:151], v3 offset:11264
    v_mfma_f32_16x16x32_bf16 v[108:111], v[156:159], v[68:71], v[108:111]
    ds_read_b64_tr_b16 v[152:153], v4 offset:10240
    ds_read_b64_tr_b16 v[154:155], v4 offset:11264
    s_waitcnt vmcnt(5) lgkmcnt(6)
    v_mfma_f32_16x16x32_bf16 v[96:99], v[160:163], v[72:75], v[96:99]
    ds_read_b64_tr_b16 v[156:157], v5 offset:10240
    ds_read_b64_tr_b16 v[158:159], v5 offset:11264
    v_mfma_f32_16x16x32_bf16 v[100:103], v[164:167], v[72:75], v[100:103]
    ds_read_b64_tr_b16 v[160:161], v2 offset:18432
    ds_read_b64_tr_b16 v[162:163], v2 offset:19456
    v_mfma_f32_16x16x32_bf16 v[104:107], v[168:171], v[72:75], v[104:107]
    ds_read_b64_tr_b16 v[164:165], v3 offset:18432
    ds_read_b64_tr_b16 v[166:167], v3 offset:19456
    v_mfma_f32_16x16x32_bf16 v[108:111], v[172:175], v[72:75], v[108:111]
    ds_read_b64_tr_b16 v[168:169], v4 offset:18432
    ds_read_b64_tr_b16 v[170:171], v4 offset:19456
    s_waitcnt vmcnt(4) lgkmcnt(6)
    v_mfma_f32_16x16x32_bf16 v[96:99], v[176:179], v[76:79], v[96:99]
    ds_read_b64_tr_b16 v[172:173], v5 offset:18432
    ds_read_b64_tr_b16 v[174:175], v5 offset:19456
    v_mfma_f32_16x16x32_bf16 v[100:103], v[180:183], v[76:79], v[100:103]
    ds_read_b64_tr_b16 v[176:177], v2 offset:26624
    ds_read_b64_tr_b16 v[178:179], v2 offset:27648
    v_mfma_f32_16x16x32_bf16 v[104:107], v[184:187], v[76:79], v[104:107]
    ds_read_b64_tr_b16 v[180:181], v3 offset:26624
    ds_read_b64_tr_b16 v[182:183], v3 offset:27648
    v_mfma_f32_16x16x32_bf16 v[108:111], v[188:191], v[76:79], v[108:111]
    ds_read_b64_tr_b16 v[184:185], v4 offset:26624
    ds_read_b64_tr_b16 v[186:187], v4 offset:27648
    s_waitcnt vmcnt(3) lgkmcnt(6)
    v_mfma_f32_16x16x32_bf16 v[96:99], v[192:195], v[80:83], v[96:99]
    ds_read_b64_tr_b16 v[188:189], v5 offset:26624
    ds_read_b64_tr_b16 v[190:191], v5 offset:27648
    v_mfma_f32_16x16x32_bf16 v[100:103], v[196:199], v[80:83], v[100:103]
    ds_read_b64_tr_b16 v[192:193], v2 offset:34816
    ds_read_b64_tr_b16 v[194:195], v2 offset:35840
    v_mfma_f32_16x16x32_bf16 v[104:107], v[200:203], v[80:83], v[104:107]
    ds_read_b64_tr_b16 v[196:197], v3 offset:34816
    ds_read_b64_tr_b16 v[198:199], v3 offset:35840
    v_mfma_f32_16x16x32_bf16 v[108:111], v[204:207], v[80:83], v[108:111]
    ds_read_b64_tr_b16 v[200:201], v4 offset:34816
    ds_read_b64_tr_b16 v[202:203], v4 offset:35840
    s_waitcnt vmcnt(2) lgkmcnt(6)
    v_mfma_f32_16x16x32_bf16 v[96:99], v[208:211], v[84:87], v[96:99]
    ds_read_b64_tr_b16 v[204:205], v5 offset:34816
    ds_read_b64_tr_b16 v[206:207], v5 offset:35840
    v_mfma_f32_16x16x32_bf16 v[100:103], v[212:215], v[84:87], v[100:103]
    ds_read_b64_tr_b16 v[208:209], v2 offset:43008
    ds_read_b64_tr_b16 v[210:211], v2 offset:44032
    v_mfma_f32_16x16x32_bf16 v[104:107], v[216:219], v[84:87], v[104:107]
    ds_read_b64_tr_b16 v[212:213], v3 offset:43008
    ds_read_b64_tr_b16 v[214:215], v3 offset:44032
    v_mfma_f32_16x16x32_bf16 v[108:111], v[220:223], v[84:87], v[108:111]
    ds_read_b64_tr_b16 v[216:217], v4 offset:43008
    ds_read_b64_tr_b16 v[218:219], v4 offset:44032
    s_waitcnt vmcnt(1) lgkmcnt(6)
    v_mfma_f32_16x16x32_bf16 v[96:99], v[224:227], v[88:91], v[96:99]
    ds_read_b64_tr_b16 v[220:221], v5 offset:43008
    ds_read_b64_tr_b16 v[222:223], v5 offset:44032
    v_mfma_f32_16x16x32_bf16 v[100:103], v[228:231], v[88:91], v[100:103]
    ds_read_b64_tr_b16 v[224:225], v2 offset:51200
    ds_read_b64_tr_b16 v[226:227], v2 offset:52224
    v_mfma_f32_16x16x32_bf16 v[104:107], v[232:235], v[88:91], v[104:107]
    ds_read_b64_tr_b16 v[228:229], v3 offset:51200
    ds_read_b64_tr_b16 v[230:231], v3 offset:52224
    v_mfma_f32_16x16x32_bf16 v[108:111], v[236:239], v[88:91], v[108:111]
    ds_read_b64_tr_b16 v[232:233], v4 offset:51200
    ds_read_b64_tr_b16 v[234:235], v4 offset:52224
    s_waitcnt vmcnt(0) lgkmcnt(6)
    v_mfma_f32_16x16x32_bf16 v[96:99], v[240:243], v[92:95], v[96:99]
    ds_read_b64_tr_b16 v[236:237], v5 offset:51200
    ds_read_b64_tr_b16 v[238:239], v5 offset:52224
    v_mfma_f32_16x16x32_bf16 v[100:103], v[244:247], v[92:95], v[100:103]
    ds_read_b64_tr_b16 v[240:241], v2 offset:59392
    ds_read_b64_tr_b16 v[242:243], v2 offset:60416
    v_mfma_f32_16x16x32_bf16 v[104:107], v[248:251], v[92:95], v[104:107]
    ds_read_b64_tr_b16 v[244:245], v3 offset:59392
    ds_read_b64_tr_b16 v[246:247], v3 offset:60416
    v_mfma_f32_16x16x32_bf16 v[108:111], v[252:255], v[92:95], v[108:111]
    ds_read_b64_tr_b16 v[248:249], v4 offset:59392
    ds_read_b64_tr_b16 v[250:251], v4 offset:60416
    s_setprio 2
    ds_read_b64_tr_b16 v[252:253], v5 offset:59392
    ds_read_b64_tr_b16 v[254:255], v5 offset:60416
    s_mov_b32 s11, 0
Lpoll_36:
    buffer_load_dword v23, v22, s[40:43], s88 offen sc1
    s_add_u32 s11, s11, 1
    s_waitcnt vmcnt(0)
    v_cmp_ne_u32 vcc, s95, v23
    s_cmp_gt_u32 s11, 200000
    s_cbranch_scc1 Lpolle_37
    s_cbranch_vccnz Lpoll_36
Lpolle_37:
    s_add_u32 s12, s87, 1048576
    s_add_u32 s13, s12, 4096
    buffer_load_dwordx4 v[64:67], v9, s[40:43], s12 offen offset:0 sc1
    buffer_load_dwordx4 v[68:71], v9, s[40:43], s12 offen offset:1024 sc1
    buffer_load_dwordx4 v[72:75], v9, s[40:43], s12 offen offset:2048 sc1
    buffer_load_dwordx4 v[76:79], v9, s[40:43], s12 offen offset:3072 sc1
    buffer_load_dwordx4 v[80:83], v9, s[40:43], s13 offen offset:0 sc1
    buffer_load_dwordx4 v[84:87], v9, s[40:43], s13 offen offset:1024 sc1
    buffer_load_dwordx4 v[88:91], v9, s[40:43], s13 offen offset:2048 sc1
    buffer_load_dwordx4 v[92:95], v9, s[40:43], s13 offen offset:3072 sc1
    s_add_u32 s88, s88, 4096
    s_waitcnt lgkmcnt(0)
    s_waitcnt vmcnt(7)
    v_mfma_f32_16x16x32_bf16 v[96:99], v[128:131], v[64:67], v[96:99]
    v_mfma_f32_16x16x32_bf16 v[100:103], v[132:135], v[64:67], v[100:103]
    v_mfma_f32_16x16x32_bf16 v[104:107], v[136:139], v[64:67], v[104:107]
    v_mfma_f32_16x16x32_bf16 v[108:111], v[140:143], v[64:67], v[108:111]
    s_waitcnt vmcnt(6)
    v_mfma_f32_16x16x32_bf16 v[96:99], v[144:147], v[68:71], v[96:99]
    v_mfma_f32_16x16x32_bf16 v[100:103], v[148:151], v[68:71], v[100:103]
    v_mfma_f32_16x16x32_bf16 v[104:107], v[152:155], v[68:71], v[104:107]
    v_mfma_f32_16x16x32_bf16 v[108:111], v[156:159], v[68:71], v[108:111]
    s_waitcnt vmcnt(5)
    v_mfma_f32_16x16x32_bf16 v[96:99], v[160:163], v[72:75], v[96:99]
    v_mfma_f32_16x16x32_bf16 v[100:103], v[164:167], v[72:75], v[100:103]
    v_mfma_f32_16x16x32_bf16 v[104:107], v[168:171], v[72:75], v[104:107]
    v_mfma_f32_16x16x32_bf16 v[108:111], v[172:175], v[72:75], v[108:111]
    s_waitcnt vmcnt(4)
    v_mfma_f32_16x16x32_bf16 v[96:99], v[176:179], v[76:79], v[96:99]
    v_mfma_f32_16x16x32_bf16 v[100:103], v[180:183], v[76:79], v[100:103]
    v_mfma_f32_16x16x32_bf16 v[104:107], v[184:187], v[76:79], v[104:107]
    v_mfma_f32_16x16x32_bf16 v[108:111], v[188:191], v[76:79], v[108:111]
    s_waitcnt vmcnt(3)
    v_mfma_f32_16x16x32_bf16 v[96:99], v[192:195], v[80:83], v[96:99]
    v_mfma_f32_16x16x32_bf16 v[100:103], v[196:199], v[80:83], v[100:103]
    v_mfma_f32_16x16x32_bf16 v[104:107], v[200:203], v[80:83], v[104:107]
    v_mfma_f32_16x16x32_bf16 v[108:111], v[204:207], v[80:83], v[108:111]
    s_waitcnt vmcnt(2)
    v_mfma_f32_16x16x32_bf16 v[96:99], v[208:211], v[84:87], v[96:99]
    v_mfma_f32_16x16x32_bf16 v[100:103], v[212:215], v[84:87], v[100:103]
    v_mfma_f32_16x16x32_bf16 v[104:107], v[216:219], v[84:87], v[104:107]
    v_mfma_f32_16x16x32_bf16 v[108:111], v[220:223], v[84:87], v[108:111]
    s_waitcnt vmcnt(1)
    v_mfma_f32_16x16x32_bf16 v[96:99], v[224:227], v[88:91], v[96:99]
    v_mfma_f32_16x16x32_bf16 v[100:103], v[228:231], v[88:91], v[100:103]
    v_mfma_f32_16x16x32_bf16 v[104:107], v[232:235], v[88:91], v[104:107]
    v_mfma_f32_16x16x32_bf16 v[108:111], v[236:239], v[88:91], v[108:111]
    s_waitcnt vmcnt(0)
    v_mfma_f32_16x16x32_bf16 v[96:99], v[240:243], v[92:95], v[96:99]
    v_mfma_f32_16x16x32_bf16 v[100:103], v[244:247], v[92:95], v[100:103]
    v_mfma_f32_16x16x32_bf16 v[104:107], v[248:251], v[92:95], v[104:107]
    v_mfma_f32_16x16x32_bf16 v[108:111], v[252:255], v[92:95], v[108:111]
    s_nop 4
    v_cvt_pk_bf16_f32 v112, v96, v97
    v_cvt_pk_bf16_f32 v113, v98, v99
    ds_write_b64 v6, v[112:113] offset:0
    v_cvt_pk_bf16_f32 v114, v100, v101
    v_cvt_pk_bf16_f32 v115, v102, v103
    ds_write_b64 v6, v[114:115] offset:32
    v_cvt_pk_bf16_f32 v116, v104, v105
    v_cvt_pk_bf16_f32 v117, v106, v107
    ds_write_b64 v6, v[116:117] offset:64
    v_cvt_pk_bf16_f32 v118, v108, v109
    v_cvt_pk_bf16_f32 v119, v110, v111
    ds_write_b64 v6, v[118:119] offset:96
    ds_read_b128 v[64:67], v7
    ds_read_b128 v[68:71], v7 offset:1152
    s_waitcnt lgkmcnt(1)
    buffer_store_dwordx4 v[64:67], v51, s[60:63], s83 offen
    s_waitcnt lgkmcnt(0)
    buffer_store_dwordx4 v[68:71], v51, s[60:63], s91 offen
L_end:
    s_endpgm
L_arole:
    s_setprio 0
    v_mov_b32 v26, 0xff800000
    v_mov_b32 v27, 0
    v_cmp_le_u32 vcc, 28, v0
    s_nop 1
    v_cndmask_b32 v88, v26, v27, vcc
    v_cndmask_b32 v92, v27, v26, vcc
    v_cmp_le_u32 vcc, 29, v0
    s_nop 1
    v_cndmask_b32 v89, v26, v27, vcc
    v_cndmask_b32 v93, v27, v26, vcc
    v_cmp_le_u32 vcc, 30, v0
    s_nop 1
    v_cndmask_b32 v90, v26, v27, vcc
    v_cndmask_b32 v94, v27, v26, vcc
    v_cmp_le_u32 vcc, 31, v0
    s_nop 1
    v_cndmask_b32 v91, v26, v27, vcc
    v_cndmask_b32 v95, v27, v26, vcc
    v_add_u32 v28, 90624, v9
    ds_write_b128 v28, v[88:91]
    ds_write_b128 v28, v[92:95] offset:1024
    v_and_b32 v22, 31, v0
    v_lshlrev_b32 v22, 2, v22
    v_mov_b32 v29, 1
    s_waitcnt lgkmcnt(0)
    ds_read_b64 v[128:129], v48 offset:0
    ds_read_b64 v[130:131], v49 offset:0
    ds_read_b128 v[160:163], v56 offset:3584
    ds_read_b128 v[164:167], v56 offset:3072
    ds_read_b128 v[168:171], v56 offset:2560
    ds_read_b128 v[172:175], v56 offset:2048
    ds_read_b128 v[176:179], v56 offset:1536
    ds_read_b128 v[180:183], v56 offset:1024
    ds_read_b128 v[184:187], v56 offset:512
    ds_read_b128 v[188:191], v56 offset:0
    ds_read_b64 v[132:133], v48 offset:2048
    ds_read_b64 v[134:135], v49 offset:2048
    ds_read_b64 v[136:137], v48 offset:4096
    ds_read_b64 v[138:139], v49 offset:4096
    s_waitcnt lgkmcnt(11)
    v_mfma_f32_16x16x32_bf16 v[96:99], v[128:131], v[160:163], 0
    ds_read_b64 v[140:141], v48 offset:6144
    s_waitcnt lgkmcnt(11)
    v_mfma_f32_16x16x32_bf16 v[100:103], v[128:131], v[164:167], 0
    ds_read_b64 v[142:143], v49 offset:6144
    s_waitcnt lgkmcnt(11)
    v_mfma_f32_16x16x32_bf16 v[104:107], v[128:131], v[168:171], 0
    ds_read_b64 v[144:145], v48 offset:8192
    s_waitcnt lgkmcnt(11)
    v_mfma_f32_16x16x32_bf16 v[108:111], v[128:131], v[172:175], 0
    ds_read_b64 v[146:147], v49 offset:8192
    s_waitcnt lgkmcnt(11)
    v_mfma_f32_16x16x32_bf16 v[112:115], v[128:131], v[176:179], 0
    ds_read_b64 v[148:149], v48 offset:10240
    s_waitcnt lgkmcnt(11)
    v_mfma_f32_16x16x32_bf16 v[116:119], v[128:131], v[180:183], 0
    ds_read_b64 v[150:151], v49 offset:10240
    s_waitcnt lgkmcnt(11)
    v_mfma_f32_16x16x32_bf16 v[120:123], v[128:131], v[184:187], 0
    ds_read_b64 v[152:153], v48 offset:12288
    s_waitcnt lgkmcnt(11)
    v_mfma_f32_16x16x32_bf16 v[124:127], v[128:131], v[188:191], 0
    ds_read_b64 v[154:155], v49 offset:12288
    s_waitcnt lgkmcnt(10)
    v_mfma_f32_16x16x32_bf16 v[100:103], v[132:135], v[160:163], v[100:103]
    ds_read_b64 v[156:157], v48 offset:14336
    v_mfma_f32_16x16x32_bf16 v[104:107], v[132:135], v[164:167], v[104:107]
    ds_read_b64 v[158:159], v49 offset:14336
    v_mfma_f32_16x16x32_bf16 v[108:111], v[132:135], v[168:171], v[108:111]
    ds_read_b64 v[192:193], v50 offset:256
    v_mfma_f32_16x16x32_bf16 v[112:115], v[132:135], v[172:175], v[112:115]
    s_waitcnt vmcnt(0)
    ds_write_b32 v24, v29
    s_waitcnt lgkmcnt(0)
    ds_read_b64 v[194:195], v51 offset:256
    v_mfma_f32_16x16x32_bf16 v[116:119], v[132:135], v[176:179], v[116:119]
    ds_read_b128 v[224:227], v56 offset:3648
    v_mfma_f32_16x16x32_bf16 v[120:123], v[132:135], v[180:183], v[120:123]
    s_waitcnt lgkmcnt(4)
    ds_read_b128 v[228:231], v56 offset:3136
    v_mfma_f32_16x16x32_bf16 v[124:127], v[132:135], v[184:187], v[124:127]
    ds_read_b128 v[232:235], v56 offset:2624
    v_mfma_f32_16x16x32_bf16 v[104:107], v[136:139], v[160:163], v[104:107]
    ds_read_b128 v[236:239], v56 offset:2112
    v_mfma_f32_16x16x32_bf16 v[108:111], v[136:139], v[164:167], v[108:111]
    ds_read_b128 v[240:243], v56 offset:1600
    v_mfma_f32_16x16x32_bf16 v[112:115], v[136:139], v[168:171], v[112:115]
    ds_read_b128 v[244:247], v56 offset:1088
    v_mfma_f32_16x16x32_bf16 v[116:119], v[136:139], v[172:175], v[116:119]
    ds_read_b128 v[248:251], v56 offset:576
    v_mfma_f32_16x16x32_bf16 v[120:123], v[136:139], v[176:179], v[120:123]
    ds_read_b128 v[252:255], v56 offset:64
    v_mfma_f32_16x16x32_bf16 v[124:127], v[136:139], v[180:183], v[124:127]
    ds_read_b64 v[196:197], v50 offset:2304
    v_mfma_f32_16x16x32_bf16 v[108:111], v[140:143], v[160:163], v[108:111]
    ds_read_b64 v[198:199], v51 offset:2304
    v_mfma_f32_16x16x32_bf16 v[112:115], v[140:143], v[164:167], v[112:115]
    ds_read_b64 v[200:201], v50 offset:4352
    v_mfma_f32_16x16x32_bf16 v[116:119], v[140:143], v[168:171], v[116:119]
    ds_read_b64 v[202:203], v51 offset:4352
    v_mfma_f32_16x16x32_bf16 v[120:123], v[140:143], v[172:175], v[120:123]
    s_waitcnt lgkmcnt(4)
    ds_read_b64 v[204:205], v50 offset:6400
    v_mfma_f32_16x16x32_bf16 v[124:127], v[140:143], v[176:179], v[124:127]
    ds_read_b64 v[206:207], v51 offset:6400
    v_mfma_f32_16x16x32_bf16 v[112:115], v[144:147], v[160:163], v[112:115]
    ds_read_b64 v[208:209], v50 offset:8448
    v_mfma_f32_16x16x32_bf16 v[116:119], v[144:147], v[164:167], v[116:119]
    ds_read_b64 v[210:211], v51 offset:8448
    v_mfma_f32_16x16x32_bf16 v[120:123], v[144:147], v[168:171], v[120:123]
    ds_read_b64 v[212:213], v50 offset:10496
    v_mfma_f32_16x16x32_bf16 v[124:127], v[144:147], v[172:175], v[124:127]
    ds_read_b64 v[214:215], v51 offset:10496
    v_mfma_f32_16x16x32_bf16 v[116:119], v[148:151], v[160:163], v[116:119]
    ds_read_b64 v[216:217], v50 offset:12544
    v_mfma_f32_16x16x32_bf16 v[120:123], v[148:151], v[164:167], v[120:123]
    ds_read_b64 v[218:219], v51 offset:12544
    v_mfma_f32_16x16x32_bf16 v[124:127], v[148:151], v[168:171], v[124:127]
    ds_read_b64 v[220:221], v50 offset:14592
    v_mfma_f32_16x16x32_bf16 v[120:123], v[152:155], v[160:163], v[120:123]
    ds_read_b64 v[222:223], v51 offset:14592
    v_mfma_f32_16x16x32_bf16 v[124:127], v[152:155], v[164:167], v[124:127]
    v_mfma_f32_16x16x32_bf16 v[124:127], v[156:159], v[160:163], v[124:127]
    s_waitcnt lgkmcnt(0)
    s_mov_b32 s11, 0
Lsy_38:
    ds_read_b32 v1, v59
    s_add_u32 s11, s11, 1
    s_cmp_gt_u32 s11, 800000
    s_waitcnt lgkmcnt(0)
    v_cmp_gt_u32 vcc, 1, v1
    s_cbranch_scc1 Lsye_39
    s_cbranch_vccnz Lsy_38
Lsye_39:
    ds_read_b64 v[28:29], v40
    s_waitcnt lgkmcnt(0)
    v_readfirstlane_b32 s10, v28
    v_readfirstlane_b32 s94, v29
    s_getreg_b32 s95, hwreg(HW_REG_XCC_ID, 0, 4)
    s_add_u32 s95, s95, 1
    s_xor_b32 s95, s95, s10
    v_mov_b32 v54, s95
    s_add_u32 s14, s38, 8388608
    s_addc_u32 s15, s39, 0
    s_cmp_lg_u32 s94, 0
    s_cselect_b32 s95, s95, s10
    s_cselect_b64 s[68:69], s[34:35], s[14:15]
    s_mov_b32 s70, 0x400000
    s_mov_b32 s71, 0x20000
    v_mov_b32 v54, s95
    s_cselect_b32 s12, 0, 128
    s_cselect_b32 s13, 0, 8192
    s_add_u32 s21, s21, s12
    s_add_u32 s92, s92, s12
    s_add_u32 s80, s80, s13
    v_mfma_f32_16x16x32_bf16 v[96:99], v[192:195], v[224:227], v[96:99]
    ds_read_b64 v[128:129], v48 offset:512
    v_mfma_f32_16x16x32_bf16 v[100:103], v[192:195], v[228:231], v[100:103]
    ds_read_b64 v[130:131], v49 offset:512
    v_mfma_f32_16x16x32_bf16 v[104:107], v[192:195], v[232:235], v[104:107]
    ds_read_b128 v[160:163], v56 offset:3712
    v_mfma_f32_16x16x32_bf16 v[108:111], v[192:195], v[236:239], v[108:111]
    ds_read_b128 v[164:167], v56 offset:3200
    v_mfma_f32_16x16x32_bf16 v[112:115], v[192:195], v[240:243], v[112:115]
    ds_read_b128 v[168:171], v56 offset:2688
    v_mfma_f32_16x16x32_bf16 v[116:119], v[192:195], v[244:247], v[116:119]
    ds_read_b128 v[172:175], v56 offset:2176
    v_mfma_f32_16x16x32_bf16 v[120:123], v[192:195], v[248:251], v[120:123]
    ds_read_b128 v[176:179], v56 offset:1664
    v_mfma_f32_16x16x32_bf16 v[124:127], v[192:195], v[252:255], v[124:127]
    ds_read_b128 v[180:183], v56 offset:1152
    v_mfma_f32_16x16x32_bf16 v[100:103], v[196:199], v[224:227], v[100:103]
    ds_read_b128 v[184:187], v56 offset:640
    v_mfma_f32_16x16x32_bf16 v[104:107], v[196:199], v[228:231], v[104:107]
    ds_read_b128 v[188:191], v56 offset:128
    v_mfma_f32_16x16x32_bf16 v[108:111], v[196:199], v[232:235], v[108:111]
    ds_read_b64 v[132:133], v48 offset:2560
    v_mfma_f32_16x16x32_bf16 v[112:115], v[196:199], v[236:239], v[112:115]
    ds_read_b64 v[134:135], v49 offset:2560
    v_mfma_f32_16x16x32_bf16 v[116:119], v[196:199], v[240:243], v[116:119]
    ds_read_b64 v[136:137], v48 offset:4608
    v_mfma_f32_16x16x32_bf16 v[120:123], v[196:199], v[244:247], v[120:123]
    ds_read_b64 v[138:139], v49 offset:4608
    v_mfma_f32_16x16x32_bf16 v[124:127], v[196:199], v[248:251], v[124:127]
    ds_read_b64 v[140:141], v48 offset:6656
    v_mfma_f32_16x16x32_bf16 v[104:107], v[200:203], v[224:227], v[104:107]
    s_waitcnt lgkmcnt(4)
    ds_read_b64 v[142:143], v49 offset:6656
    v_mfma_f32_16x16x32_bf16 v[108:111], v[200:203], v[228:231], v[108:111]
    ds_read_b64 v[144:145], v48 offset:8704
    v_mfma_f32_16x16x32_bf16 v[112:115], v[200:203], v[232:235], v[112:115]
    ds_read_b64 v[146:147], v49 offset:8704
    v_mfma_f32_16x16x32_bf16 v[116:119], v[200:203], v[236:239], v[116:119]
    ds_read_b64 v[148:149], v48 offset:10752
    v_mfma_f32_16x16x32_bf16 v[120:123], v[200:203], v[240:243], v[120:123]
    ds_read_b64 v[150:151], v49 offset:10752
    v_mfma_f32_16x16x32_bf16 v[124:127], v[200:203], v[244:247], v[124:127]
    ds_read_b64 v[152:153], v48 offset:12800
    v_mfma_f32_16x16x32_bf16 v[108:111], v[204:207], v[224:227], v[108:111]
    ds_read_b64 v[154:155], v49 offset:12800
    v_mfma_f32_16x16x32_bf16 v[112:115], v[204:207], v[228:231], v[112:115]
    ds_read_b64 v[156:157], v48 offset:14848
    v_mfma_f32_16x16x32_bf16 v[116:119], v[204:207], v[232:235], v[116:119]
    ds_read_b64 v[158:159], v49 offset:14848
    v_mfma_f32_16x16x32_bf16 v[120:123], v[204:207], v[236:239], v[120:123]
    v_mfma_f32_16x16x32_bf16 v[124:127], v[204:207], v[240:243], v[124:127]
    v_mfma_f32_16x16x32_bf16 v[112:115], v[208:211], v[224:227], v[112:115]
    v_mfma_f32_16x16x32_bf16 v[116:119], v[208:211], v[228:231], v[116:119]
    v_mfma_f32_16x16x32_bf16 v[120:123], v[208:211], v[232:235], v[120:123]
    v_mfma_f32_16x16x32_bf16 v[124:127], v[208:211], v[236:239], v[124:127]
    v_mfma_f32_16x16x32_bf16 v[116:119], v[212:215], v[224:227], v[116:119]
    v_mfma_f32_16x16x32_bf16 v[120:123], v[212:215], v[228:231], v[120:123]
    v_mfma_f32_16x16x32_bf16 v[124:127], v[212:215], v[232:235], v[124:127]
    v_mfma_f32_16x16x32_bf16 v[120:123], v[216:219], v[224:227], v[120:123]
    v_mfma_f32_16x16x32_bf16 v[124:127], v[216:219], v[228:231], v[124:127]
    v_mfma_f32_16x16x32_bf16 v[124:127], v[220:223], v[224:227], v[124:127]
    v_mfma_f32_16x16x32_bf16 v[96:99], v[128:131], v[160:163], v[96:99]
    ds_read_b64 v[192:193], v52 offset:768
    v_mfma_f32_16x16x32_bf16 v[100:103], v[128:131], v[164:167], v[100:103]
    ds_read_b64 v[194:195], v53 offset:768
    v_mfma_f32_16x16x32_bf16 v[104:107], v[128:131], v[168:171], v[104:107]
    s_waitcnt lgkmcnt(4)
    ds_read_b128 v[224:227], v56 offset:3776
    v_mfma_f32_16x16x32_bf16 v[108:111], v[128:131], v[172:175], v[108:111]
    ds_read_b128 v[228:231], v56 offset:3264
    v_mfma_f32_16x16x32_bf16 v[112:115], v[128:131], v[176:179], v[112:115]
    ds_read_b128 v[232:235], v56 offset:2752
    v_mfma_f32_16x16x32_bf16 v[116:119], v[128:131], v[180:183], v[116:119]
    ds_read_b128 v[236:239], v56 offset:2240
    v_mfma_f32_16x16x32_bf16 v[120:123], v[128:131], v[184:187], v[120:123]
    ds_read_b128 v[240:243], v56 offset:1728
    v_mfma_f32_16x16x32_bf16 v[124:127], v[128:131], v[188:191], v[124:127]
    ds_read_b128 v[244:247], v56 offset:1216
    v_mfma_f32_16x16x32_bf16 v[100:103], v[132:135], v[160:163], v[100:103]
    ds_read_b128 v[248:251], v56 offset:704
    v_mfma_f32_16x16x32_bf16 v[104:107], v[132:135], v[164:167], v[104:107]
    ds_read_b128 v[252:255], v56 offset:192
    v_mfma_f32_16x16x32_bf16 v[108:111], v[132:135], v[168:171], v[108:111]
    ds_read_b64 v[196:197], v52 offset:2816
    v_mfma_f32_16x16x32_bf16 v[112:115], v[132:135], v[172:175], v[112:115]
    ds_read_b64 v[198:199], v53 offset:2816
    v_mfma_f32_16x16x32_bf16 v[116:119], v[132:135], v[176:179], v[116:119]
    ds_read_b64 v[200:201], v52 offset:4864
    v_mfma_f32_16x16x32_bf16 v[120:123], v[132:135], v[180:183], v[120:123]
    s_waitcnt lgkmcnt(4)
    ds_read_b64 v[202:203], v53 offset:4864
    v_mfma_f32_16x16x32_bf16 v[124:127], v[132:135], v[184:187], v[124:127]
    ds_read_b64 v[204:205], v52 offset:6912
    v_mfma_f32_16x16x32_bf16 v[104:107], v[136:139], v[160:163], v[104:107]
    ds_read_b64 v[206:207], v53 offset:6912
    v_mfma_f32_16x16x32_bf16 v[108:111], v[136:139], v[164:167], v[108:111]
    ds_read_b64 v[208:209], v52 offset:8960
    v_mfma_f32_16x16x32_bf16 v[112:115], v[136:139], v[168:171], v[112:115]
    ds_read_b64 v[210:211], v53 offset:8960
    v_mfma_f32_16x16x32_bf16 v[116:119], v[136:139], v[172:175], v[116:119]
    ds_read_b64 v[212:213], v52 offset:11008
    v_mfma_f32_16x16x32_bf16 v[120:123], v[136:139], v[176:179], v[120:123]
    ds_read_b64 v[214:215], v53 offset:11008
    v_mfma_f32_16x16x32_bf16 v[124:127], v[136:139], v[180:183], v[124:127]
    ds_read_b64 v[216:217], v52 offset:13056
    v_mfma_f32_16x16x32_bf16 v[108:111], v[140:143], v[160:163], v[108:111]
    ds_read_b64 v[218:219], v53 offset:13056
    v_mfma_f32_16x16x32_bf16 v[112:115], v[140:143], v[164:167], v[112:115]
    ds_read_b64 v[220:221], v52 offset:15104
    v_mfma_f32_16x16x32_bf16 v[116:119], v[140:143], v[168:171], v[116:119]
    ds_read_b64 v[222:223], v53 offset:15104
    v_mfma_f32_16x16x32_bf16 v[120:123], v[140:143], v[172:175], v[120:123]
    v_mfma_f32_16x16x32_bf16 v[124:127], v[140:143], v[176:179], v[124:127]
    v_mfma_f32_16x16x32_bf16 v[112:115], v[144:147], v[160:163], v[112:115]
    v_mfma_f32_16x16x32_bf16 v[116:119], v[144:147], v[164:167], v[116:119]
    v_mfma_f32_16x16x32_bf16 v[120:123], v[144:147], v[168:171], v[120:123]
    v_mfma_f32_16x16x32_bf16 v[124:127], v[144:147], v[172:175], v[124:127]
    v_mfma_f32_16x16x32_bf16 v[116:119], v[148:151], v[160:163], v[116:119]
    v_mfma_f32_16x16x32_bf16 v[120:123], v[148:151], v[164:167], v[120:123]
    v_mfma_f32_16x16x32_bf16 v[124:127], v[148:151], v[168:171], v[124:127]
    v_mfma_f32_16x16x32_bf16 v[120:123], v[152:155], v[160:163], v[120:123]
    v_mfma_f32_16x16x32_bf16 v[124:127], v[152:155], v[164:167], v[124:127]
    v_mfma_f32_16x16x32_bf16 v[124:127], v[156:159], v[160:163], v[124:127]
    v_mfma_f32_16x16x32_bf16 v[96:99], v[192:195], v[224:227], v[96:99]
    v_mfma_f32_16x16x32_bf16 v[100:103], v[192:195], v[228:231], v[100:103]
    v_mfma_f32_16x16x32_bf16 v[104:107], v[192:195], v[232:235], v[104:107]
    v_mfma_f32_16x16x32_bf16 v[108:111], v[192:195], v[236:239], v[108:111]
    v_mfma_f32_16x16x32_bf16 v[112:115], v[192:195], v[240:243], v[112:115]
    v_mfma_f32_16x16x32_bf16 v[116:119], v[192:195], v[244:247], v[116:119]
    v_mfma_f32_16x16x32_bf16 v[120:123], v[192:195], v[248:251], v[120:123]
    s_waitcnt lgkmcnt(0)
    v_mfma_f32_16x16x32_bf16 v[124:127], v[192:195], v[252:255], v[124:127]
    v_mfma_f32_16x16x32_bf16 v[100:103], v[196:199], v[224:227], v[100:103]
    v_mfma_f32_16x16x32_bf16 v[104:107], v[196:199], v[228:231], v[104:107]
    v_mfma_f32_16x16x32_bf16 v[108:111], v[196:199], v[232:235], v[108:111]
    v_mfma_f32_16x16x32_bf16 v[112:115], v[196:199], v[236:239], v[112:115]
    v_mfma_f32_16x16x32_bf16 v[116:119], v[196:199], v[240:243], v[116:119]
    v_mfma_f32_16x16x32_bf16 v[120:123], v[196:199], v[244:247], v[120:123]
    v_mfma_f32_16x16x32_bf16 v[124:127], v[196:199], v[248:251], v[124:127]
    v_mfma_f32_16x16x32_bf16 v[104:107], v[200:203], v[224:227], v[104:107]
    v_mfma_f32_16x16x32_bf16 v[108:111], v[200:203], v[228:231], v[108:111]
    v_mfma_f32_16x16x32_bf16 v[112:115], v[200:203], v[232:235], v[112:115]
    v_mfma_f32_16x16x32_bf16 v[116:119], v[200:203], v[236:239], v[116:119]
    v_mfma_f32_16x16x32_bf16 v[120:123], v[200:203], v[240:243], v[120:123]
    v_mfma_f32_16x16x32_bf16 v[124:127], v[200:203], v[244:247], v[124:127]
    v_mfma_f32_16x16x32_bf16 v[108:111], v[204:207], v[224:227], v[108:111]
    v_mfma_f32_16x16x32_bf16 v[112:115], v[204:207], v[228:231], v[112:115]
    v_mfma_f32_16x16x32_bf16 v[116:119], v[204:207], v[232:235], v[116:119]
    v_mfma_f32_16x16x32_bf16 v[120:123], v[204:207], v[236:239], v[120:123]
    v_mfma_f32_16x16x32_bf16 v[124:127], v[204:207], v[240:243], v[124:127]
    v_mfma_f32_16x16x32_bf16 v[112:115], v[208:211], v[224:227], v[112:115]
    v_mfma_f32_16x16x32_bf16 v[116:119], v[208:211], v[228:231], v[116:119]
    v_mfma_f32_16x16x32_bf16 v[120:123], v[208:211], v[232:235], v[120:123]
    v_mfma_f32_16x16x32_bf16 v[124:127], v[208:211], v[236:239], v[124:127]
    v_mfma_f32_16x16x32_bf16 v[116:119], v[212:215], v[224:227], v[116:119]
    v_mfma_f32_16x16x32_bf16 v[120:123], v[212:215], v[228:231], v[120:123]
    v_mfma_f32_16x16x32_bf16 v[124:127], v[212:215], v[232:235], v[124:127]
    v_mfma_f32_16x16x32_bf16 v[120:123], v[216:219], v[224:227], v[120:123]
    v_mfma_f32_16x16x32_bf16 v[124:127], v[216:219], v[228:231], v[124:127]
    v_mfma_f32_16x16x32_bf16 v[124:127], v[220:223], v[224:227], v[124:127]
    s_waitcnt lgkmcnt(0)
    s_setprio 3
    s_mov_b32 s11, 0
Lsy_40:
    ds_read_b32 v1, v30
    s_add_u32 s11, s11, 1
    s_cmp_gt_u32 s11, 800000
    s_waitcnt lgkmcnt(0)
    v_cmp_gt_u32 vcc, 2, v1
    s_cbranch_scc1 Lsye_41
    s_cbranch_vccnz Lsy_40
Lsye_41:
    s_bitcmp1_b32 s9, 0
    s_cbranch_scc1 Lred_42
    ds_write_b128 v36, v[112:115] offset:28672
    ds_write_b128 v36, v[116:119] offset:29696
    ds_write_b128 v36, v[120:123] offset:30720
    ds_write_b128 v36, v[124:127] offset:31744
    v_mov_b32 v1, 3
    ds_write_b32 v24, v1
    s_mov_b32 s11, 0
Lsy_44:
    ds_read_b32 v1, v62
    s_add_u32 s11, s11, 1
    s_cmp_gt_u32 s11, 800000
    s_waitcnt lgkmcnt(0)
    v_cmp_gt_u32 vcc, 3, v1
    s_cbranch_scc1 Lsye_45
    s_cbranch_vccnz Lsy_44
Lsye_45:
    ds_read_b128 v[64:67], v36 offset:0
    ds_read_b128 v[68:71], v36 offset:1024
    ds_read_b128 v[72:75], v36 offset:2048
    ds_read_b128 v[76:79], v36 offset:3072
    s_waitcnt lgkmcnt(3)
    v_add_f32 v64, v64, v96
    v_add_f32 v65, v65, v97
    v_add_f32 v66, v66, v98
    v_add_f32 v67, v67, v99
    s_waitcnt lgkmcnt(2)
    v_add_f32 v68, v68, v100
    v_add_f32 v69, v69, v101
    v_add_f32 v70, v70, v102
    v_add_f32 v71, v71, v103
    s_waitcnt lgkmcnt(1)
    v_add_f32 v72, v72, v104
    v_add_f32 v73, v73, v105
    v_add_f32 v74, v74, v106
    v_add_f32 v75, v75, v107
    s_waitcnt lgkmcnt(0)
    v_add_f32 v76, v76, v108
    v_add_f32 v77, v77, v109
    v_add_f32 v78, v78, v110
    v_add_f32 v79, v79, v111
    s_branch Lredj_43
Lred_42:
    ds_write_b128 v36, v[96:99] offset:0
    ds_write_b128 v36, v[100:103] offset:1024
    ds_write_b128 v36, v[104:107] offset:2048
    ds_write_b128 v36, v[108:111] offset:3072
    v_mov_b32 v1, 3
    ds_write_b32 v24, v1
    s_mov_b32 s11, 0
Lsy_46:
    ds_read_b32 v1, v62
    s_add_u32 s11, s11, 1
    s_cmp_gt_u32 s11, 800000
    s_waitcnt lgkmcnt(0)
    v_cmp_gt_u32 vcc, 3, v1
    s_cbranch_scc1 Lsye_47
    s_cbranch_vccnz Lsy_46
Lsye_47:
    ds_read_b128 v[64:67], v36 offset:28672
    ds_read_b128 v[68:71], v36 offset:29696
    ds_read_b128 v[72:75], v36 offset:30720
    ds_read_b128 v[76:79], v36 offset:31744
    s_waitcnt lgkmcnt(3)
    v_add_f32 v64, v64, v112
    v_add_f32 v65, v65, v113
    v_add_f32 v66, v66, v114
    v_add_f32 v67, v67, v115
    s_waitcnt lgkmcnt(2)
    v_add_f32 v68, v68, v116
    v_add_f32 v69, v69, v117
    v_add_f32 v70, v70, v118
    v_add_f32 v71, v71, v119
    s_waitcnt lgkmcnt(1)
    v_add_f32 v72, v72, v120
    v_add_f32 v73, v73, v121
    v_add_f32 v74, v74, v122
    v_add_f32 v75, v75, v123
    s_waitcnt lgkmcnt(0)
    v_add_f32 v76, v76, v124
    v_add_f32 v77, v77, v125
    v_add_f32 v78, v78, v126
    v_add_f32 v79, v79, v127
Lredj_43:
    v_cvt_pk_bf16_f32 v80, v64, v65
    v_cvt_pk_bf16_f32 v81, v66, v67
    v_cvt_pk_bf16_f32 v82, v68, v69
    v_cvt_pk_bf16_f32 v83, v70, v71
    v_cvt_pk_bf16_f32 v84, v72, v73
    v_cvt_pk_bf16_f32 v85, v74, v75
    v_cvt_pk_bf16_f32 v86, v76, v77
    v_cvt_pk_bf16_f32 v87, v78, v79
    s_add_u32 s12, s20, 0x100000
    s_nop 0
    v_permlane16_swap_b32 v80, v82
    v_permlane16_swap_b32 v81, v83
    v_permlane16_swap_b32 v84, v86
    v_permlane16_swap_b32 v85, v87
    s_cmp_eq_u32 s94, 0
    s_cbranch_scc1 Lfar_48
    buffer_store_dwordx4 v[80:83], v35, s[68:71], s20 offen
    buffer_store_dwordx4 v[84:87], v35, s[68:71], s12 offen
Lfarj_49:
    v_mov_b32 v1, 4
    ds_write_b32 v24, v1
    ds_read_b128 v[160:163], v19 offset:1408
    ds_read_b128 v[164:167], v19 offset:1280
    ds_read_b128 v[168:171], v19 offset:1152
    ds_read_b128 v[172:175], v19 offset:1024
    ds_read_b128 v[176:179], v19 offset:384
    ds_read_b128 v[180:183], v19 offset:256
    ds_read_b128 v[184:187], v19 offset:128
    ds_read_b128 v[188:191], v19 offset:0
    s_cmp_eq_u32 s94, 0
    s_mov_b64 exec, 1
    s_waitcnt vmcnt(0)
    s_cbranch_scc1 Lfar_50
    buffer_store_dword v54, off, s[40:43], s21
Lfarj_51:
    s_mov_b64 exec, -1
    s_mov_b32 s11, 0
Lsy_52:
    ds_read_b32 v1, v59
    s_add_u32 s11, s11, 1
    s_cmp_gt_u32 s11, 800000
    s_waitcnt lgkmcnt(0)
    v_cmp_gt_u32 vcc, 3, v1
    s_cbranch_scc1 Lsye_53
    s_cbranch_vccnz Lsy_52
Lsye_53:
    s_mov_b64 exec, 0x7ffff
    buffer_load_dword v27, v39, s[40:43], 0 offen sc1
    s_mov_b64 exec, -1
    s_add_u32 s11, s16, 0
    s_and_b32 s11, s11, 7
    s_lshl_b32 s12, s11, 11
    s_add_u32 m0, s12, s17
    s_lshl_b32 s11, s11, 14
    s_add_u32 s11, s11, s18
    buffer_load_dwordx4 v32, s[56:59], s11 offen lds
    buffer_load_dwordx4 v33, s[56:59], s11 offen offset:1024 lds
    s_add_u32 s11, s16, 1
    s_and_b32 s11, s11, 7
    s_lshl_b32 s12, s11, 11
    s_add_u32 m0, s12, s17
    s_lshl_b32 s11, s11, 14
    s_add_u32 s11, s11, s18
    buffer_load_dwordx4 v32, s[56:59], s11 offen lds
    buffer_load_dwordx4 v33, s[56:59], s11 offen offset:1024 lds
    s_add_u32 s11, s16, 2
    s_and_b32 s11, s11, 7
    s_lshl_b32 s12, s11, 11
    s_add_u32 m0, s12, s17
    s_lshl_b32 s11, s11, 14
    s_add_u32 s11, s11, s18
    buffer_load_dwordx4 v32, s[56:59], s11 offen lds
    buffer_load_dwordx4 v33, s[56:59], s11 offen offset:1024 lds
    s_add_u32 s11, s16, 3
    s_and_b32 s11, s11, 7
    s_lshl_b32 s12, s11, 11
    s_add_u32 m0, s12, s17
    s_lshl_b32 s11, s11, 14
    s_add_u32 s11, s11, s18
    buffer_load_dwordx4 v32, s[56:59], s11 offen lds
    buffer_load_dwordx4 v33, s[56:59], s11 offen offset:1024 lds
    s_mul_i32 s87, s9, 2080
    s_add_u32 m0, s87, 82304
    s_add_u32 s12, s88, 8192
    buffer_load_dwordx4 v8, s[52:55], s88 offen lds
    s_add_u32 m0, s87, 83344
    s_nop 0
    buffer_load_dwordx4 v8, s[52:55], s12 offen lds
    s_setprio 1
    s_mov_b32 s11, 0
Lsy_54:
    ds_read_b32 v1, v30
    s_add_u32 s11, s11, 1
    s_cmp_gt_u32 s11, 800000
    s_waitcnt lgkmcnt(0)
    v_cmp_gt_u32 vcc, 5, v1
    s_cbranch_scc1 Lsye_55
    s_cbranch_vccnz Lsy_54
Lsye_55:
    ds_read_b128 v[12:15], v34
    ds_read_b128 v[200:203], v16 offset:8256
    ds_read_b128 v[204:207], v16 offset:6192
    ds_read_b128 v[208:211], v17 offset:8256
    ds_read_b128 v[212:215], v18 offset:8256
    s_waitcnt lgkmcnt(3)
    v_mfma_f32_32x32x16_bf16 v[128:143], v[200:203], v[12:15], 0
    s_nop 11
    v_exp_f32 v128, v128
    v_exp_f32 v129, v129
    v_exp_f32 v130, v130
    v_exp_f32 v131, v131
    v_cvt_pk_bf16_f32 v192, v128, v129
    v_exp_f32 v132, v132
    v_exp_f32 v133, v133
    v_cvt_pk_bf16_f32 v193, v130, v131
    s_waitcnt lgkmcnt(0)
    v_mfma_f32_32x32x16_bf16 v[144:159], v[204:207], v[12:15], 0
    ds_read_b128 v[200:203], v16 offset:10320
    v_exp_f32 v134, v134
    v_exp_f32 v135, v135
    v_cvt_pk_bf16_f32 v194, v132, v133
    v_exp_f32 v136, v136
    v_exp_f32 v137, v137
    v_cvt_pk_bf16_f32 v195, v134, v135
    v_exp_f32 v138, v138
    v_exp_f32 v139, v139
    v_mfma_f32_32x32x16_bf16 v[96:111], v[208:211], v[192:195], 0
    ds_read_b128 v[216:219], v17 offset:6192
    ds_read_b128 v[220:223], v18 offset:6192
    v_cvt_pk_bf16_f32 v196, v136, v137
    v_exp_f32 v140, v140
    v_exp_f32 v141, v141
    v_cvt_pk_bf16_f32 v197, v138, v139
    v_exp_f32 v142, v142
    v_exp_f32 v143, v143
    v_cvt_pk_bf16_f32 v198, v140, v141
    v_cvt_pk_bf16_f32 v199, v142, v143
    v_exp_f32 v144, v144
    v_exp_f32 v145, v145
    v_mfma_f32_32x32x16_bf16 v[96:111], v[212:215], v[196:199], v[96:111]
    v_exp_f32 v146, v146
    v_exp_f32 v147, v147
    v_cvt_pk_bf16_f32 v192, v144, v145
    v_exp_f32 v148, v148
    v_exp_f32 v149, v149
    v_cvt_pk_bf16_f32 v193, v146, v147
    s_waitcnt lgkmcnt(0)
    v_mfma_f32_32x32x16_bf16 v[128:143], v[200:203], v[12:15], 0
    ds_read_b128 v[204:207], v16 offset:4128
    v_exp_f32 v150, v150
    v_exp_f32 v151, v151
    v_cvt_pk_bf16_f32 v194, v148, v149
    v_exp_f32 v152, v152
    v_exp_f32 v153, v153
    v_cvt_pk_bf16_f32 v195, v150, v151
    v_exp_f32 v154, v154
    v_exp_f32 v155, v155
    v_mfma_f32_32x32x16_bf16 v[96:111], v[216:219], v[192:195], v[96:111]
    ds_read_b128 v[208:211], v17 offset:10320
    ds_read_b128 v[212:215], v18 offset:10320
    v_cvt_pk_bf16_f32 v196, v152, v153
    v_exp_f32 v156, v156
    v_exp_f32 v157, v157
    v_cvt_pk_bf16_f32 v197, v154, v155
    v_exp_f32 v158, v158
    v_exp_f32 v159, v159
    v_cvt_pk_bf16_f32 v198, v156, v157
    v_cvt_pk_bf16_f32 v199, v158, v159
    v_exp_f32 v128, v128
    v_exp_f32 v129, v129
    v_mfma_f32_32x32x16_bf16 v[96:111], v[220:223], v[196:199], v[96:111]
    v_exp_f32 v130, v130
    v_exp_f32 v131, v131
    v_cvt_pk_bf16_f32 v192, v128, v129
    v_exp_f32 v132, v132
    v_exp_f32 v133, v133
    v_cvt_pk_bf16_f32 v193, v130, v131
    s_waitcnt lgkmcnt(0)
    v_mfma_f32_32x32x16_bf16 v[144:159], v[204:207], v[12:15], 0
    ds_read_b128 v[200:203], v16 offset:12384
    v_exp_f32 v134, v134
    v_exp_f32 v135, v135
    v_cvt_pk_bf16_f32 v194, v132, v133
    v_exp_f32 v136, v136
    v_exp_f32 v137, v137
    v_cvt_pk_bf16_f32 v195, v134, v135
    v_exp_f32 v138, v138
    v_exp_f32 v139, v139
    v_mfma_f32_32x32x16_bf16 v[96:111], v[208:211], v[192:195], v[96:111]
    ds_read_b128 v[216:219], v17 offset:4128
    ds_read_b128 v[220:223], v18 offset:4128
    v_cvt_pk_bf16_f32 v196, v136, v137
    v_exp_f32 v140, v140
    v_exp_f32 v141, v141
    v_cvt_pk_bf16_f32 v197, v138, v139
    v_exp_f32 v142, v142
    v_exp_f32 v143, v143
    v_cvt_pk_bf16_f32 v198, v140, v141
    v_cvt_pk_bf16_f32 v199, v142, v143
    v_exp_f32 v144, v144
    v_exp_f32 v145, v145
    v_mfma_f32_32x32x16_bf16 v[96:111], v[212:215], v[196:199], v[96:111]
    v_exp_f32 v146, v146
    v_exp_f32 v147, v147
    v_cvt_pk_bf16_f32 v192, v144, v145
    v_exp_f32 v148, v148
    v_exp_f32 v149, v149
    v_cvt_pk_bf16_f32 v193, v146, v147
    s_waitcnt lgkmcnt(0)
    v_mfma_f32_32x32x16_bf16 v[128:143], v[200:203], v[12:15], 0
    ds_read_b128 v[204:207], v16 offset:2064
    v_exp_f32 v150, v150
    v_exp_f32 v151, v151
    v_cvt_pk_bf16_f32 v194, v148, v149
    v_exp_f32 v152, v152
    v_exp_f32 v153, v153
    v_cvt_pk_bf16_f32 v195, v150, v151
    v_exp_f32 v154, v154
    v_exp_f32 v155, v155
    v_mfma_f32_32x32x16_bf16 v[96:111], v[216:219], v[192:195], v[96:111]
    ds_read_b128 v[208:211], v17 offset:12384
    ds_read_b128 v[212:215], v18 offset:12384
    v_cvt_pk_bf16_f32 v196, v152, v153
    v_exp_f32 v156, v156
    v_exp_f32 v157, v157
    v_cvt_pk_bf16_f32 v197, v154, v155
    v_exp_f32 v158, v158
    v_exp_f32 v159, v159
    v_cvt_pk_bf16_f32 v198, v156, v157
    v_cvt_pk_bf16_f32 v199, v158, v159
    s_waitcnt vmcnt(0)
    v_mov_b32 v1, 5
    ds_write_b32 v24, v1
    v_exp_f32 v128, v128
    v_exp_f32 v129, v129
    v_mfma_f32_32x32x16_bf16 v[96:111], v[220:223], v[196:199], v[96:111]
    v_exp_f32 v130, v130
    v_exp_f32 v131, v131
    v_cvt_pk_bf16_f32 v192, v128, v129
    v_exp_f32 v132, v132
    v_exp_f32 v133, v133
    v_cvt_pk_bf16_f32 v193, v130, v131
    s_waitcnt lgkmcnt(0)
    v_mfma_f32_32x32x16_bf16 v[144:159], v[204:207], v[12:15], 0
    ds_read_b128 v[200:203], v16 offset:14448
    v_exp_f32 v134, v134
    v_exp_f32 v135, v135
    v_cvt_pk_bf16_f32 v194, v132, v133
    v_exp_f32 v136, v136
    v_exp_f32 v137, v137
    v_cvt_pk_bf16_f32 v195, v134, v135
    v_exp_f32 v138, v138
    v_exp_f32 v139, v139
    v_mfma_f32_32x32x16_bf16 v[96:111], v[208:211], v[192:195], v[96:111]
    ds_read_b128 v[216:219], v17 offset:2064
    ds_read_b128 v[220:223], v18 offset:2064
    v_cvt_pk_bf16_f32 v196, v136, v137
    v_exp_f32 v140, v140
    v_exp_f32 v141, v141
    v_cvt_pk_bf16_f32 v197, v138, v139
    v_exp_f32 v142, v142
    v_exp_f32 v143, v143
    v_cvt_pk_bf16_f32 v198, v140, v141
    v_cvt_pk_bf16_f32 v199, v142, v143
    v_exp_f32 v144, v144
    v_exp_f32 v145, v145
    v_mfma_f32_32x32x16_bf16 v[96:111], v[212:215], v[196:199], v[96:111]
    v_exp_f32 v146, v146
    v_exp_f32 v147, v147
    v_cvt_pk_bf16_f32 v192, v144, v145
    v_exp_f32 v148, v148
    v_exp_f32 v149, v149
    v_cvt_pk_bf16_f32 v193, v146, v147
    s_waitcnt lgkmcnt(0)
    v_mfma_f32_32x32x16_bf16 v[128:143], v[200:203], v[12:15], 0
    ds_read_b128 v[204:207], v16 offset:0
    v_exp_f32 v150, v150
    v_exp_f32 v151, v151
    v_cvt_pk_bf16_f32 v194, v148, v149
    v_exp_f32 v152, v152
    v_exp_f32 v153, v153
    v_cvt_pk_bf16_f32 v195, v150, v151
    v_exp_f32 v154, v154
    v_exp_f32 v155, v155
    v_mfma_f32_32x32x16_bf16 v[96:111], v[216:219], v[192:195], v[96:111]
    ds_read_b128 v[208:211], v17 offset:14448
    ds_read_b128 v[212:215], v18 offset:14448
    v_cvt_pk_bf16_f32 v196, v152, v153
    v_exp_f32 v156, v156
    v_exp_f32 v157, v157
    v_cvt_pk_bf16_f32 v197, v154, v155
    v_exp_f32 v158, v158
    v_exp_f32 v159, v159
    v_cvt_pk_bf16_f32 v198, v156, v157
    v_cvt_pk_bf16_f32 v199, v158, v159
    buffer_load_dword v23, v22, s[40:43], s92 offen sc1
    v_exp_f32 v128, v128
    v_exp_f32 v129, v129
    v_mfma_f32_32x32x16_bf16 v[96:111], v[220:223], v[196:199], v[96:111]
    v_exp_f32 v130, v130
    v_exp_f32 v131, v131
    v_cvt_pk_bf16_f32 v192, v128, v129
    v_exp_f32 v132, v132
    v_exp_f32 v133, v133
    v_cvt_pk_bf16_f32 v193, v130, v131
    s_waitcnt lgkmcnt(0)
    v_mfma_f32_32x32x16_bf16 v[144:159], v[204:207], v[12:15], v[160:175]
    ds_read_b128 v[200:203], v16 offset:16512
    v_exp_f32 v134, v134
    v_exp_f32 v135, v135
    v_cvt_pk_bf16_f32 v194, v132, v133
    v_exp_f32 v136, v136
    v_exp_f32 v137, v137
    v_cvt_pk_bf16_f32 v195, v134, v135
    v_exp_f32 v138, v138
    v_exp_f32 v139, v139
    v_mfma_f32_32x32x16_bf16 v[96:111], v[208:211], v[192:195], v[96:111]
    ds_read_b128 v[216:219], v17 offset:0
    ds_read_b128 v[220:223], v18 offset:0
    v_cvt_pk_bf16_f32 v196, v136, v137
    v_exp_f32 v140, v140
    v_exp_f32 v141, v141
    v_cvt_pk_bf16_f32 v197, v138, v139
    v_exp_f32 v142, v142
    v_exp_f32 v143, v143
    v_cvt_pk_bf16_f32 v198, v140, v141
    v_cvt_pk_bf16_f32 v199, v142, v143
    v_exp_f32 v144, v144
    v_exp_f32 v145, v145
    v_mfma_f32_32x32x16_bf16 v[96:111], v[212:215], v[196:199], v[96:111]
    v_exp_f32 v146, v146
    v_exp_f32 v147, v147
    v_cvt_pk_bf16_f32 v192, v144, v145
    v_exp_f32 v148, v148
    v_exp_f32 v149, v149
    v_cvt_pk_bf16_f32 v193, v146, v147
    s_waitcnt lgkmcnt(0)
    v_mfma_f32_32x32x16_bf16 v[128:143], v[200:203], v[12:15], v[176:191]
    v_exp_f32 v150, v150
    v_exp_f32 v151, v151
    v_cvt_pk_bf16_f32 v194, v148, v149
    v_exp_f32 v152, v152
    v_exp_f32 v153, v153
    v_cvt_pk_bf16_f32 v195, v150, v151
    v_exp_f32 v154, v154
    v_exp_f32 v155, v155
    v_mfma_f32_32x32x16_bf16 v[96:111], v[216:219], v[192:195], v[96:111]
    ds_read_b128 v[208:211], v17 offset:16512
    ds_read_b128 v[212:215], v18 offset:16512
    v_cvt_pk_bf16_f32 v196, v152, v153
    v_exp_f32 v156, v156
    v_exp_f32 v157, v157
    v_cvt_pk_bf16_f32 v197, v154, v155
    v_exp_f32 v158, v158
    v_exp_f32 v159, v159
    v_cvt_pk_bf16_f32 v198, v156, v157
    v_cvt_pk_bf16_f32 v199, v158, v159
    s_waitcnt vmcnt(0)
    v_cmp_ne_u32 vcc, s95, v23
    s_mov_b32 s11, 0
    s_cbranch_vccz Lpolle_57
Lpoll_56:
    buffer_load_dword v23, v22, s[40:43], s92 offen sc1
    s_add_u32 s11, s11, 1
    s_waitcnt vmcnt(0)
    v_cmp_ne_u32 vcc, s95, v23
    s_cmp_gt_u32 s11, 200000
    s_cbranch_scc1 Lpolle_57
    s_cbranch_vccnz Lpoll_56
Lpolle_57:
    buffer_load_dwordx4 v[224:227], v60, s[68:71], s19 offen sc1
    buffer_load_dwordx4 v[228:231], v60, s[68:71], s19 offen offset:2048 sc1
    v_exp_f32 v128, v128
    v_exp_f32 v129, v129
    v_mfma_f32_32x32x16_bf16 v[96:111], v[220:223], v[196:199], v[96:111]
    v_exp_f32 v130, v130
    v_exp_f32 v131, v131
    v_cvt_pk_bf16_f32 v192, v128, v129
    v_exp_f32 v132, v132
    v_exp_f32 v133, v133
    v_cvt_pk_bf16_f32 v193, v130, v131
    s_waitcnt lgkmcnt(0)
    v_exp_f32 v134, v134
    v_exp_f32 v135, v135
    v_cvt_pk_bf16_f32 v194, v132, v133
    v_exp_f32 v136, v136
    v_exp_f32 v137, v137
    v_cvt_pk_bf16_f32 v195, v134, v135
    v_exp_f32 v138, v138
    v_exp_f32 v139, v139
    v_mfma_f32_32x32x16_bf16 v[96:111], v[208:211], v[192:195], v[96:111]
    v_cvt_pk_bf16_f32 v196, v136, v137
    v_exp_f32 v140, v140
    v_exp_f32 v141, v141
    v_cvt_pk_bf16_f32 v197, v138, v139
    v_exp_f32 v142, v142
    v_exp_f32 v143, v143
    v_cvt_pk_bf16_f32 v198, v140, v141
    v_cvt_pk_bf16_f32 v199, v142, v143
    s_nop 1
    v_mfma_f32_32x32x16_bf16 v[96:111], v[212:215], v[196:199], v[96:111]
    s_nop 11
    v_cmp_nge_f32 vcc, v104, s77
    v_cmp_nle_f32 s[14:15], v104, s78
    s_or_b64 vcc, vcc, s[14:15]
    s_cbranch_vccnz L_slow1
L_back1:
    v_rcp_f32 v104, v104
    s_nop 0
    v_pk_mul_f32 v[96:97], v[96:97], v[104:105] op_sel_hi:[1,0]
    v_pk_mul_f32 v[98:99], v[98:99], v[104:105] op_sel_hi:[1,0]
    v_pk_mul_f32 v[100:101], v[100:101], v[104:105] op_sel_hi:[1,0]
    v_pk_mul_f32 v[102:103], v[102:103], v[104:105] op_sel_hi:[1,0]
    v_cvt_pk_bf16_f32 v232, v96, v97
    v_cvt_pk_bf16_f32 v233, v98, v99
    v_cvt_pk_bf16_f32 v234, v100, v101
    v_cvt_pk_bf16_f32 v235, v102, v103
    s_cmp_eq_u32 s94, 0
    s_cbranch_scc1 Lfar_58
    buffer_store_dwordx4 v[232:235], v20, s[40:43], s79 offen
Lfarj_59:
    s_cmp_eq_u32 s94, 0
    s_mov_b64 exec, 1
    s_waitcnt vmcnt(0)
    s_cbranch_scc1 Lfar_60
    buffer_store_dword v54, off, s[40:43], s80
Lfarj_61:
    s_mov_b64 exec, -1
    s_setprio 0
    s_mov_b32 s11, 0
Lsy_62:
    ds_read_b32 v1, v25
    s_add_u32 s11, s11, 1
    s_cmp_gt_u32 s11, 800000
    s_waitcnt lgkmcnt(0)
    v_cmp_gt_u32 vcc, 5, v1
    s_cbranch_scc1 Lsye_63
    s_cbranch_vccnz Lsy_62
Lsye_63:
    ds_read2_b32 v[64:65], v57 offset0:0 offset1:32
    ds_read2_b32 v[66:67], v57 offset0:64 offset1:96
    ds_read2_b32 v[68:69], v57 offset0:128 offset1:160
    ds_read2_b32 v[70:71], v57 offset0:192 offset1:224
    s_waitcnt vmcnt(2)
    v_lshlrev_b32 v72, 16, v224
    v_lshlrev_b32 v73, 16, v228
    s_waitcnt lgkmcnt(0)
    v_lshlrev_b32 v76, 16, v64
    v_and_b32 v77, 0xffff0000, v64
    v_mul_f32 v72, v72, v76
    v_mul_f32 v73, v73, v77
    v_cvt_pk_bf16_f32 v88, v72, v73
    v_and_b32 v80, 0xffff0000, v224
    v_and_b32 v81, 0xffff0000, v228
    v_lshlrev_b32 v84, 16, v65
    v_and_b32 v85, 0xffff0000, v65
    v_mul_f32 v80, v80, v84
    v_mul_f32 v81, v81, v85
    v_cvt_pk_bf16_f32 v89, v80, v81
    v_lshlrev_b32 v72, 16, v225
    v_lshlrev_b32 v73, 16, v229
    v_lshlrev_b32 v76, 16, v66
    v_and_b32 v77, 0xffff0000, v66
    v_mul_f32 v72, v72, v76
    v_mul_f32 v73, v73, v77
    v_cvt_pk_bf16_f32 v90, v72, v73
    v_and_b32 v80, 0xffff0000, v225
    v_and_b32 v81, 0xffff0000, v229
    v_lshlrev_b32 v84, 16, v67
    v_and_b32 v85, 0xffff0000, v67
    v_mul_f32 v80, v80, v84
    v_mul_f32 v81, v81, v85
    v_cvt_pk_bf16_f32 v91, v80, v81
    v_lshlrev_b32 v72, 16, v226
    v_lshlrev_b32 v73, 16, v230
    v_lshlrev_b32 v76, 16, v68
    v_and_b32 v77, 0xffff0000, v68
    v_mul_f32 v72, v72, v76
    v_mul_f32 v73, v73, v77
    v_cvt_pk_bf16_f32 v92, v72, v73
    v_and_b32 v80, 0xffff0000, v226
    v_and_b32 v81, 0xffff0000, v230
    v_lshlrev_b32 v84, 16, v69
    v_and_b32 v85, 0xffff0000, v69
    v_mul_f32 v80, v80, v84
    v_mul_f32 v81, v81, v85
    v_cvt_pk_bf16_f32 v93, v80, v81
    v_lshlrev_b32 v72, 16, v227
    v_lshlrev_b32 v73, 16, v231
    v_lshlrev_b32 v76, 16, v70
    v_and_b32 v77, 0xffff0000, v70
    v_mul_f32 v72, v72, v76
    v_mul_f32 v73, v73, v77
    v_cvt_pk_bf16_f32 v94, v72, v73
    v_and_b32 v80, 0xffff0000, v227
    v_and_b32 v81, 0xffff0000, v231
    v_lshlrev_b32 v84, 16, v71
    v_and_b32 v85, 0xffff0000, v71
    v_mul_f32 v80, v80, v84
    v_mul_f32 v81, v81, v85
    v_cvt_pk_bf16_f32 v95, v80, v81
    ds_write2_b32 v57, v88, v89 offset0:0 offset1:32
    ds_write2_b32 v57, v90, v91 offset0:64 offset1:96
    ds_write2_b32 v57, v92, v93 offset0:128 offset1:160
    ds_write2_b32 v57, v94, v95 offset0:192 offset1:224
    v_mov_b32 v1, 6
    ds_write_b32 v24, v1
    s_mov_b32 s60, s34
    s_mov_b32 s61, s35
    s_mov_b32 s62, 4194304
    s_mov_b32 s63, 0x20000
    s_add_u32 s13, s19, 16384
    s_mov_b32 s11, 0
Lsy_64:
    ds_read_b32 v1, v25
    s_add_u32 s11, s11, 1
    s_cmp_gt_u32 s11, 800000
    s_waitcnt lgkmcnt(0)
    v_cmp_gt_u32 vcc, 6, v1
    s_cbranch_scc1 Lsye_65
    s_cbranch_vccnz Lsy_64
Lsye_65:
    ds_read_b128 v[64:67], v38
    ds_read_b128 v[68:71], v38 offset:1040
    s_waitcnt lgkmcnt(0)
    buffer_store_dwordx4 v[64:67], v37, s[60:63], s19 offen
    buffer_store_dwordx4 v[68:71], v37, s[60:63], s13 offen
    s_endpgm
L_slow0:
    s_lshl_b32 s82, s6, 2
    s_add_u32 s82, s82, s9
    s_sub_u32 s82, 8, s82
    s_max_i32 s82, s82, 0
    v_mov_b32 v144, 0xff800000
    v_mov_b32 v96, 0
    v_mov_b32 v97, 0
    v_mov_b32 v98, 0
    v_mov_b32 v99, 0
    v_mov_b32 v100, 0
    v_mov_b32 v101, 0
    v_mov_b32 v102, 0
    v_mov_b32 v103, 0
    v_mov_b32 v104, 0
    v_mov_b32 v105, 0
    v_mov_b32 v106, 0
    v_mov_b32 v107, 0
    v_mov_b32 v108, 0
    v_mov_b32 v109, 0
    v_mov_b32 v110, 0
    v_mov_b32 v111, 0
    s_mov_b32 s81, s82
Lsl_66:
    s_mul_i32 s12, s81, 2064
    v_add_u32 v145, s12, v16
    v_add_u32 v146, s12, v17
    v_add_u32 v147, s12, v18
    ds_read_b128 v[200:203], v145
    ds_read_b128 v[208:211], v146
    ds_read_b128 v[212:215], v147
    s_waitcnt lgkmcnt(0)
    s_cmp_eq_u32 s81, 0
    s_cbranch_scc1 Lsl_67
    s_cmp_eq_u32 s81, 8
    s_cbranch_scc1 Lsl_68
    v_mfma_f32_32x32x16_bf16 v[128:143], v[200:203], v[12:15], 0
    s_branch Lsl_69
Lsl_67:
    v_mfma_f32_32x32x16_bf16 v[128:143], v[200:203], v[12:15], v[160:175]
    s_branch Lsl_69
Lsl_68:
    v_mfma_f32_32x32x16_bf16 v[128:143], v[200:203], v[12:15], v[176:191]
Lsl_69:
    s_nop 15
    v_max3_f32 v144, v144, v128, v129
    v_max3_f32 v144, v144, v130, v131
    v_max3_f32 v144, v144, v132, v133
    v_max3_f32 v144, v144, v134, v135
    v_max3_f32 v144, v144, v136, v137
    v_max3_f32 v144, v144, v138, v139
    v_max3_f32 v144, v144, v140, v141
    v_max3_f32 v144, v144, v142, v143
    s_add_u32 s81, s81, 1
    s_cmp_le_u32 s81, 8
    s_cbranch_scc1 Lsl_66
    v_mov_b32 v145, v144
    s_nop 1
    v_permlane32_swap_b32 v144, v145
    s_nop 1
    v_max_f32 v144, v144, v145
    s_mov_b32 s81, s82
Lsl_70:
    s_mul_i32 s12, s81, 2064
    v_add_u32 v145, s12, v16
    v_add_u32 v146, s12, v17
    v_add_u32 v147, s12, v18
    ds_read_b128 v[200:203], v145
    ds_read_b128 v[208:211], v146
    ds_read_b128 v[212:215], v147
    s_waitcnt lgkmcnt(0)
    s_cmp_eq_u32 s81, 0
    s_cbranch_scc1 Lsl_71
    s_cmp_eq_u32 s81, 8
    s_cbranch_scc1 Lsl_72
    v_mfma_f32_32x32x16_bf16 v[128:143], v[200:203], v[12:15], 0
    s_branch Lsl_73
Lsl_71:
    v_mfma_f32_32x32x16_bf16 v[128:143], v[200:203], v[12:15], v[160:175]
    s_branch Lsl_73
Lsl_72:
    v_mfma_f32_32x32x16_bf16 v[128:143], v[200:203], v[12:15], v[176:191]
Lsl_73:
    s_nop 15
    v_sub_f32 v128, v128, v144
    v_sub_f32 v129, v129, v144
    v_sub_f32 v130, v130, v144
    v_sub_f32 v131, v131, v144
    v_sub_f32 v132, v132, v144
    v_sub_f32 v133, v133, v144
    v_sub_f32 v134, v134, v144
    v_sub_f32 v135, v135, v144
    v_sub_f32 v136, v136, v144
    v_sub_f32 v137, v137, v144
    v_sub_f32 v138, v138, v144
    v_sub_f32 v139, v139, v144
    v_sub_f32 v140, v140, v144
    v_sub_f32 v141, v141, v144
    v_sub_f32 v142, v142, v144
    v_sub_f32 v143, v143, v144
    v_exp_f32 v128, v128
    v_exp_f32 v129, v129
    v_exp_f32 v130, v130
    v_exp_f32 v131, v131
    v_exp_f32 v132, v132
    v_exp_f32 v133, v133
    v_exp_f32 v134, v134
    v_exp_f32 v135, v135
    v_exp_f32 v136, v136
    v_exp_f32 v137, v137
    v_exp_f32 v138, v138
    v_exp_f32 v139, v139
    v_exp_f32 v140, v140
    v_exp_f32 v141, v141
    v_exp_f32 v142, v142
    v_exp_f32 v143, v143
    s_nop 0
    v_cvt_pk_bf16_f32 v192, v128, v129
    v_cvt_pk_bf16_f32 v193, v130, v131
    v_cvt_pk_bf16_f32 v194, v132, v133
    v_cvt_pk_bf16_f32 v195, v134, v135
    v_cvt_pk_bf16_f32 v196, v136, v137
    v_cvt_pk_bf16_f32 v197, v138, v139
    v_cvt_pk_bf16_f32 v198, v140, v141
    v_cvt_pk_bf16_f32 v199, v142, v143
    s_nop 1
    v_mfma_f32_32x32x16_bf16 v[96:111], v[208:211], v[192:195], v[96:111]
    v_mfma_f32_32x32x16_bf16 v[96:111], v[212:215], v[196:199], v[96:111]
    s_nop 15
    s_add_u32 s81, s81, 1
    s_cmp_le_u32 s81, 8
    s_cbranch_scc1 Lsl_70
    s_branch L_back0
L_slow1:
    s_lshl_b32 s82, s6, 2
    s_add_u32 s82, s82, s9
    s_sub_u32 s82, 8, s82
    s_max_i32 s82, s82, 0
    v_mov_b32 v144, 0xff800000
    v_mov_b32 v96, 0
    v_mov_b32 v97, 0
    v_mov_b32 v98, 0
    v_mov_b32 v99, 0
    v_mov_b32 v100, 0
    v_mov_b32 v101, 0
    v_mov_b32 v102, 0
    v_mov_b32 v103, 0
    v_mov_b32 v104, 0
    v_mov_b32 v105, 0
    v_mov_b32 v106, 0
    v_mov_b32 v107, 0
    v_mov_b32 v108, 0
    v_mov_b32 v109, 0
    v_mov_b32 v110, 0
    v_mov_b32 v111, 0
    s_mov_b32 s81, s82
Lsl_74:
    s_mul_i32 s12, s81, 2064
    v_add_u32 v145, s12, v16
    v_add_u32 v146, s12, v17
    v_add_u32 v147, s12, v18
    ds_read_b128 v[200:203], v145
    ds_read_b128 v[208:211], v146
    ds_read_b128 v[212:215], v147
    s_waitcnt lgkmcnt(0)
    s_cmp_eq_u32 s81, 0
    s_cbranch_scc1 Lsl_75
    s_cmp_eq_u32 s81, 8
    s_cbranch_scc1 Lsl_76
    v_mfma_f32_32x32x16_bf16 v[128:143], v[200:203], v[12:15], 0
    s_branch Lsl_77
Lsl_75:
    v_mfma_f32_32x32x16_bf16 v[128:143], v[200:203], v[12:15], v[160:175]
    s_branch Lsl_77
Lsl_76:
    v_mfma_f32_32x32x16_bf16 v[128:143], v[200:203], v[12:15], v[176:191]
Lsl_77:
    s_nop 15
    v_max3_f32 v144, v144, v128, v129
    v_max3_f32 v144, v144, v130, v131
    v_max3_f32 v144, v144, v132, v133
    v_max3_f32 v144, v144, v134, v135
    v_max3_f32 v144, v144, v136, v137
    v_max3_f32 v144, v144, v138, v139
    v_max3_f32 v144, v144, v140, v141
    v_max3_f32 v144, v144, v142, v143
    s_add_u32 s81, s81, 1
    s_cmp_le_u32 s81, 8
    s_cbranch_scc1 Lsl_74
    v_mov_b32 v145, v144
    s_nop 1
    v_permlane32_swap_b32 v144, v145
    s_nop 1
    v_max_f32 v144, v144, v145
    s_mov_b32 s81, s82
Lsl_78:
    s_mul_i32 s12, s81, 2064
    v_add_u32 v145, s12, v16
    v_add_u32 v146, s12, v17
    v_add_u32 v147, s12, v18
    ds_read_b128 v[200:203], v145
    ds_read_b128 v[208:211], v146
    ds_read_b128 v[212:215], v147
    s_waitcnt lgkmcnt(0)
    s_cmp_eq_u32 s81, 0
    s_cbranch_scc1 Lsl_79
    s_cmp_eq_u32 s81, 8
    s_cbranch_scc1 Lsl_80
    v_mfma_f32_32x32x16_bf16 v[128:143], v[200:203], v[12:15], 0
    s_branch Lsl_81
Lsl_79:
    v_mfma_f32_32x32x16_bf16 v[128:143], v[200:203], v[12:15], v[160:175]
    s_branch Lsl_81
Lsl_80:
    v_mfma_f32_32x32x16_bf16 v[128:143], v[200:203], v[12:15], v[176:191]
Lsl_81:
    s_nop 15
    v_sub_f32 v128, v128, v144
    v_sub_f32 v129, v129, v144
    v_sub_f32 v130, v130, v144
    v_sub_f32 v131, v131, v144
    v_sub_f32 v132, v132, v144
    v_sub_f32 v133, v133, v144
    v_sub_f32 v134, v134, v144
    v_sub_f32 v135, v135, v144
    v_sub_f32 v136, v136, v144
    v_sub_f32 v137, v137, v144
    v_sub_f32 v138, v138, v144
    v_sub_f32 v139, v139, v144
    v_sub_f32 v140, v140, v144
    v_sub_f32 v141, v141, v144
    v_sub_f32 v142, v142, v144
    v_sub_f32 v143, v143, v144
    v_exp_f32 v128, v128
    v_exp_f32 v129, v129
    v_exp_f32 v130, v130
    v_exp_f32 v131, v131
    v_exp_f32 v132, v132
    v_exp_f32 v133, v133
    v_exp_f32 v134, v134
    v_exp_f32 v135, v135
    v_exp_f32 v136, v136
    v_exp_f32 v137, v137
    v_exp_f32 v138, v138
    v_exp_f32 v139, v139
    v_exp_f32 v140, v140
    v_exp_f32 v141, v141
    v_exp_f32 v142, v142
    v_exp_f32 v143, v143
    s_nop 0
    v_cvt_pk_bf16_f32 v192, v128, v129
    v_cvt_pk_bf16_f32 v193, v130, v131
    v_cvt_pk_bf16_f32 v194, v132, v133
    v_cvt_pk_bf16_f32 v195, v134, v135
    v_cvt_pk_bf16_f32 v196, v136, v137
    v_cvt_pk_bf16_f32 v197, v138, v139
    v_cvt_pk_bf16_f32 v198, v140, v141
    v_cvt_pk_bf16_f32 v199, v142, v143
    s_nop 1
    v_mfma_f32_32x32x16_bf16 v[96:111], v[208:211], v[192:195], v[96:111]
    v_mfma_f32_32x32x16_bf16 v[96:111], v[212:215], v[196:199], v[96:111]
    s_nop 15
    s_add_u32 s81, s81, 1
    s_cmp_le_u32 s81, 8
    s_cbranch_scc1 Lsl_78
    s_branch L_back1
Lum_3:
    s_mov_b32 s11, 0
Lul_5:
    s_add_u32 s11, s11, 1
    s_cmp_eq_u32 s11, 24
    s_cbranch_scc0 Lun_6
    s_add_u32 s68, s38, 8388608
    s_addc_u32 s69, s39, 0
    s_mov_b32 s70, 0x400000
    s_mov_b32 s71, 0x20000
    buffer_store_dwordx4 v[40:43], v61, s[68:71], s91 offen sc1
    buffer_store_dwordx4 v[44:47], v61, s[68:71], s91 offen offset:2048 sc1
    s_add_u32 s12, s92, 128
    s_waitcnt vmcnt(0)
    s_mov_b64 exec, 1
    buffer_store_dword v21, off, s[40:43], s12 sc1
    s_mov_b64 exec, -1
Lun_6:
    buffer_load_dword v23, v22, s[40:43], s93 offen sc1
    s_waitcnt vmcnt(0)
    v_cmp_ne_u32 vcc, v55, v23
    s_mov_b32 s94, 1
    s_cmp_eq_u32 vcc_lo, 0
    s_cbranch_scc1 Luj_4
    s_mov_b32 s94, 0
    s_cmp_gt_u32 s11, 200000
    s_cbranch_scc1 Luj_4
    s_cmp_lt_u32 s11, 24
    s_cbranch_scc1 Lul_5
    s_cmp_lg_u32 vcc_hi, 0
    s_cbranch_scc1 Lul_5
    buffer_load_dword v23, v22, s[40:43], s93 offen sc1
    s_waitcnt vmcnt(0)
    v_cmp_ne_u32 vcc, v55, v23
    s_mov_b32 s94, 1
    s_cmp_eq_u32 vcc_lo, 0
    s_cbranch_scc1 Luj_4
    s_mov_b32 s94, 0
    s_branch Luj_4
Lum_9:
    s_mov_b32 s11, 0
Lul_11:
    s_add_u32 s11, s11, 1
    s_cmp_eq_u32 s11, 24
    s_cbranch_scc0 Lun_12
    s_add_u32 s68, s38, 8388608
    s_addc_u32 s69, s39, 0
    s_mov_b32 s70, 0x400000
    s_mov_b32 s71, 0x20000
    buffer_store_dwordx4 v[40:43], v61, s[68:71], s91 offen sc1
    buffer_store_dwordx4 v[44:47], v61, s[68:71], s91 offen offset:2048 sc1
    s_add_u32 s12, s92, 128
    s_waitcnt vmcnt(0)
    s_mov_b64 exec, 1
    buffer_store_dword v21, off, s[40:43], s12 sc1
    s_mov_b64 exec, -1
Lun_12:
    buffer_load_dword v23, v22, s[40:43], s93 offen sc1
    s_waitcnt vmcnt(0)
    v_cmp_ne_u32 vcc, v55, v23
    s_mov_b32 s94, 1
    s_cmp_eq_u32 vcc_lo, 0
    s_cbranch_scc1 Luj_10
    s_mov_b32 s94, 0
    s_cmp_gt_u32 s11, 200000
    s_cbranch_scc1 Luj_10
    s_cmp_lt_u32 s11, 24
    s_cbranch_scc1 Lul_11
    s_cmp_lg_u32 vcc_hi, 0
    s_cbranch_scc1 Lul_11
    buffer_load_dword v23, v22, s[40:43], s93 offen sc1
    s_waitcnt vmcnt(0)
    v_cmp_ne_u32 vcc, v55, v23
    s_mov_b32 s94, 1
    s_cmp_eq_u32 vcc_lo, 0
    s_cbranch_scc1 Luj_10
    s_mov_b32 s94, 0
    s_branch Luj_10
Lfar_24:
    buffer_store_dwordx4 v[232:235], v20, s[40:43], s79 offen sc1
    s_branch Lfarj_25
Lfar_26:
    buffer_store_dword v54, off, s[40:43], s80 sc1
    s_branch Lfarj_27
Lfar_48:
    buffer_store_dwordx4 v[80:83], v35, s[68:71], s20 offen sc1
    buffer_store_dwordx4 v[84:87], v35, s[68:71], s12 offen sc1
    s_branch Lfarj_49
Lfar_50:
    buffer_store_dword v54, off, s[40:43], s21 sc1
    s_branch Lfarj_51
Lfar_58:
    buffer_store_dwordx4 v[232:235], v20, s[40:43], s79 offen sc1
    s_branch Lfarj_59
Lfar_60:
    buffer_store_dword v54, off, s[40:43], s80 sc1
    s_branch Lfarj_61
.section .rodata,"a"
.p2align 6
.amdhsa_kernel concat_heads__ssm_conv_h3__sliding_block__prompt_kernel
  .amdhsa_next_free_vgpr 256
  .amdhsa_next_free_sgpr 102
  .amdhsa_accum_offset 256
  .amdhsa_group_segment_fixed_size 0
  .amdhsa_kernarg_size 96
  .amdhsa_user_sgpr_count 2
  .amdhsa_user_sgpr_kernarg_segment_ptr 1
  .amdhsa_system_sgpr_workgroup_id_x 1
.end_amdhsa_kernel
```
